```python
import torch

def _softmax(x, axis=-1):
    return torch.softmax(x, dim=axis)
def _gelu(x):
    return torch.nn.functional.gelu(x, approximate="tanh")
def _silu(x):
    return torch.nn.functional.silu(x)
def _sigmoid(x):
    return torch.sigmoid(x)
def _layernorm(x, axis=-1, eps=1e-5):
    m = x.mean(dim=axis, keepdim=True)
    v = x.var(dim=axis, keepdim=True, unbiased=False)
    return (x - m) / torch.sqrt(v + eps)
def _scatter_add(tgt, idx, src, axis=0):
    return tgt.clone().index_add_(axis, idx, src)
def _segment_sum(src, seg, n):
    out = torch.zeros((n,) + src.shape[1:], dtype=src.dtype)
    return out.index_add_(0, seg, src)
def _pad(x, pw):
    flat = tuple(v for pair in reversed(pw) for v in pair)
    return torch.nn.functional.pad(x, flat)

kernel_name = 'sequential_preLN__sliding_block_cached__dense_activation_relu__decode'

def setup_inputs():

    _w = (lambda a: (lambda t: t.to(torch.bfloat16) if t.is_floating_point() else t)(torch.as_tensor(a)))
    def _A_setup():
        B, Sq, D = 1, 1, 640
        Hq, Hkv, Sk, Dh = 32, 32, 32768, 192
        assert Hq % Hkv == 0, (Hq, Hkv)
        return {
            "x": _w((lambda *s: torch.randn(*s, dtype=torch.bfloat16) * 0.05)(B, Sq, D)),
            "k_cache": _w((lambda *s: torch.randn(*s, dtype=torch.bfloat16) * 3.2)(B, Hkv, Sk, Dh)),
            "v_cache": _w((lambda *s: torch.randn(*s, dtype=torch.bfloat16) * 0.4)(B, Hkv, Sk, Dh)),
            "wq": _w((lambda *s: torch.randn(*s, dtype=torch.bfloat16) * 3.2)(D, Hq * Dh) * (D ** -0.5)),
            "wo": _w((lambda *s: torch.randn(*s, dtype=torch.bfloat16) * 0.4)(Hq * Dh, D) * ((Hq * Dh) ** -0.5)),
        }
    _A_in = _A_setup()

    def _B_setup():
        B, S, D, Dff = 1, 1, 640, 1536
        return {
            "x": _w((lambda *s: torch.randn(*s, dtype=torch.bfloat16) * 0.05)(B, S, D)),
            "w1": _w((lambda *s: torch.randn(*s, dtype=torch.bfloat16) * 0.05)(D, Dff)),
            "w2": _w((lambda *s: torch.randn(*s, dtype=torch.bfloat16) * 0.05)(Dff, D)),
        }
    _B_in = _B_setup()

    return {
        "A_x": _A_in["x"],
        "A_k_cache": _A_in["k_cache"],
        "A_v_cache": _A_in["v_cache"],
        "A_wq": _A_in["wq"],
        "A_wo": _A_in["wo"],
        "B_x": _B_in["x"],
        "B_w1": _B_in["w1"],
        "B_w2": _B_in["w2"],
    }

def reference(A_x, A_k_cache, A_v_cache, A_wq, A_wo, B_x, B_w1, B_w2):
    def _A_ref(x, k_cache, v_cache, wq, wo):
        B, Sq, D = x.shape
        Hq, Dh = 32, 192
        Hkv, Sk = k_cache.shape[1], k_cache.shape[2]
        W = min(4096, max(256, Sk // 4))
        rep = Hq // Hkv
        q = (lambda x, *d: x.permute(*d))((x @ wq).reshape(B, Sq, Hq, Dh), 0, 2, 1, 3)
        k = (lambda x, n, axis: torch.repeat_interleave(x, n, dim=axis))(k_cache[:, :, Sk - W:, :], rep, axis=1)
        v = (lambda x, n, axis: torch.repeat_interleave(x, n, dim=axis))(v_cache[:, :, Sk - W:, :], rep, axis=1)
        scores = torch.einsum("bhqd,bhkd->bhqk", q, k) * (Dh ** -0.5)
        p = _softmax(scores, axis=-1)
        o = torch.einsum("bhqk,bhkd->bhqd", p, v)
        return (lambda x, *d: x.permute(*d))(o, 0, 2, 1, 3).reshape(B, Sq, Hq * Dh) @ wo

    def _B_ref(x, w1, w2):
        h = torch.einsum("bsd,df->bsf", x, w1)
        zero = torch.zeros_like(h)
        h = torch.maximum(h, zero)
        return torch.einsum("bsf,fd->bsd", h, w2)

    x = A_x
    h = x + _A_ref(_layernorm(x, axis=-1), A_k_cache, A_v_cache, A_wq, A_wo)
    h2 = h + _B_ref(_layernorm(h, axis=-1), B_w1, B_w2)
    return h2
```

```asm
; @launch grid=(256,1,1) block=(512,1,1) lds=86016
.amdgcn_target "amdgcn-amd-amdhsa--gfx950"
.text
.globl sequential_preLN__sliding_block_cached__dense_activation_relu__decode_kernel
.p2align 8
.type sequential_preLN__sliding_block_cached__dense_activation_relu__decode_kernel,@function
sequential_preLN__sliding_block_cached__dense_activation_relu__decode_kernel:
    s_load_dwordx16 s[4:19], s[0:1], 0
    s_load_dwordx4 s[20:23], s[0:1], 64
    s_load_dwordx2 s[24:25], s[0:1], 80
    s_cmp_ge_u32 s2, 256
    s_cbranch_scc1 L_end
    v_lshrrev_b32 v1, 6, v0
    s_getpc_b64 s[50:51]
    s_and_b32 s34, s2, 0x78
    v_add_lshl_u32 v7, v1, s34, 7
    v_readfirstlane_b32 s26, v1
    global_load_dword v31, v7, s[50:51]
    v_and_b32 v0, 63, v0
    s_and_b32 s27, s2, 7
    s_lshr_b32 s28, s2, 3
    s_lshr_b32 s29, s28, 3
    s_lshl2_add_u32 s29, s27, s29
    s_and_b32 s30, s28, 7
    s_lshl3_add_u32 s34, s30, s26
    s_mul_i32 s34, s34, 122880
    s_mul_i32 s35, s29, 384
    s_add_u32 s34, s34, s35
    v_lshl_add_u32 v5, v0, 4, s34
    v_add_u32 v6, 11904, v5
    v_cmp_lt_u32 vcc, 23, v0
    s_mul_i32 s35, s26, 3840
    s_add_u32 m0, s35, 20480
    v_cndmask_b32 v5, v5, v6, vcc
    s_mov_b32 exec_hi, 0xffff
    s_waitcnt lgkmcnt(0)
    global_load_lds_dwordx4 v5, s[10:11] nt
    s_add_u32 m0, m0, 768
    v_add_u32 v5, 24576, v5
    global_load_lds_dwordx4 v5, s[10:11] nt
    s_add_u32 m0, m0, 768
    v_add_u32 v5, 24576, v5
    global_load_lds_dwordx4 v5, s[10:11] nt
    s_add_u32 m0, m0, 768
    v_add_u32 v5, 24576, v5
    global_load_lds_dwordx4 v5, s[10:11] nt
    s_add_u32 m0, m0, 768
    v_add_u32 v5, 24576, v5
    global_load_lds_dwordx4 v5, s[10:11] nt
    s_lshl_b32 s34, s27, 5
    s_add_u32 s34, s34, s28
    s_mul_i32 s69, s34, 1152
    s_mul_i32 s35, s26, 384
    s_add_u32 s34, s69, s35
    v_mov_b32 v16, -1
    v_mov_b32 v17, -1
    v_lshl_add_u32 v6, v0, 3, s34
    s_cmp_ge_u32 s26, 3
    s_cbranch_scc1 L_rst2
    v_add_u32 v6, 524288, v6
    global_store_dwordx2 v6, v[16:17], s[24:25] sc1
    s_branch L_norst
L_rst2:
    s_cmp_ge_u32 s26, 6
    s_cbranch_scc1 L_norst
    v_add_u32 v6, 850816, v6
    global_store_dwordx2 v6, v[16:17], s[24:25]
L_norst:
    s_mov_b64 exec, -1
    v_lshlrev_b32 v7, 2, v0
    v_mov_b32 v11, 0
    ds_write_b32 v7, v11
    s_mul_i32 s34, s29, 12582912
    s_lshl3_add_u32 s35, s26, s30
    s_mul_i32 s35, s35, 3072
    s_add_u32 s34, s34, s35
    s_add_u32 s34, s34, 11010048
    s_and_b32 s66, s29, 7
    s_mov_b32 s68, 196608
    s_mul_i32 s35, s66, s68
    s_add_u32 s34, s34, s35
    v_and_b32 v2, 15, v0
    v_lshrrev_b32 v3, 4, v0
    v_lshrrev_b32 v24, 2, v2
    v_mul_u32_u24 v24, 704, v24
    v_lshl_add_u32 v24, v2, 4, v24
    v_lshl_add_u32 v24, v3, 6, v24
    v_add_u32 v4, s34, v24
    s_cmp_eq_u32 s26, 7
    s_cbranch_scc1 L_control
    v_mul_u32_u24 v24, 768, v3
    v_lshl_add_u32 v24, v2, 4, v24
    v_add_u32 v8, s34, v24
    s_mov_b32 s40, 0x00ff00ff
    s_mov_b32 s41, 0x00ff00ff
    s_mov_b32 s42, 0x00ff00ff
    s_mov_b32 s43, 0xff00ff00
    s_mov_b32 s44, 0xff00ff00
    s_mov_b32 s45, 0xff00ff00
    v_and_b32 v24, 1, v0
    v_lshlrev_b32 v24, 4, v24
    v_mov_b32 v25, 0xffff
    v_lshlrev_b32 v24, v24, v25
    v_bfe_u32 v25, v0, 1, 2
    v_cmp_eq_u32 vcc, 0, v25
    s_nop 1
    v_cndmask_b32 v12, 0, v24, vcc
    v_cmp_eq_u32 vcc, 1, v25
    s_nop 1
    v_cndmask_b32 v13, 0, v24, vcc
    v_cmp_eq_u32 vcc, 2, v25
    s_nop 1
    v_cndmask_b32 v14, 0, v24, vcc
    v_cmp_eq_u32 vcc, 3, v25
    s_nop 1
    v_cndmask_b32 v15, 0, v24, vcc
    v_and_b32 v28, 3, v2
    v_lshl_add_u32 v28, v3, 2, v28
    v_lshlrev_b32 v28, 4, v28
    v_add_u32 v28, 256, v28
    v_mov_b32 v24, 192
    v_add_u32 v29, 256, v28
    v_subrev_u32 v30, 128, v28
    v_cmp_gt_u32 vcc, 32, v0
    s_nop 1
    v_cndmask_b32 v29, v30, v29, vcc
    v_add_u32 v30, 128, v28
    v_cndmask_b32 v28, v24, v28, s[40:41]
    v_cndmask_b32 v29, v24, v29, s[42:43]
    v_cndmask_b32 v30, v24, v30, s[44:45]
    s_waitcnt vmcnt(0)
    global_load_dwordx4 v[32:35], v4, s[6:7] offset:0 nt
    global_load_dwordx4 v[36:39], v4, s[6:7] offset:256 nt
    global_load_dwordx4 v[40:43], v4, s[6:7] offset:512 nt
    s_cmp_eq_u32 s66, 7
    s_cselect_b32 s67, -1376256, s68
    v_add_u32 v4, s67, v4
    s_waitcnt lgkmcnt(0)
    s_barrier
    s_waitcnt vmcnt(0)
    global_load_dwordx4 v[44:47], v4, s[6:7] offset:0 nt
    global_load_dwordx4 v[48:51], v4, s[6:7] offset:256 nt
    global_load_dwordx4 v[52:55], v4, s[6:7] offset:512 nt
    s_cmp_eq_u32 s66, 6
    s_cselect_b32 s67, -1376256, s68
    v_add_u32 v4, s67, v4
    s_waitcnt vmcnt(0)
    global_load_dwordx4 v[56:59], v4, s[6:7] offset:0 nt
    global_load_dwordx4 v[60:63], v4, s[6:7] offset:256 nt
    global_load_dwordx4 v[64:67], v4, s[6:7] offset:512 nt
    s_cmp_eq_u32 s66, 5
    s_cselect_b32 s67, -1376256, s68
    v_add_u32 v4, s67, v4
    s_waitcnt vmcnt(0)
    global_load_dwordx4 v[68:71], v4, s[6:7] offset:0 nt
    global_load_dwordx4 v[72:75], v4, s[6:7] offset:256 nt
    global_load_dwordx4 v[76:79], v4, s[6:7] offset:512 nt
    s_cmp_eq_u32 s66, 4
    s_cselect_b32 s67, -1376256, s68
    v_add_u32 v4, s67, v4
    s_waitcnt vmcnt(0)
    global_load_dwordx4 v[80:83], v4, s[6:7] offset:0 nt
    global_load_dwordx4 v[84:87], v4, s[6:7] offset:256 nt
    global_load_dwordx4 v[88:91], v4, s[6:7] offset:512 nt
    s_cmp_eq_u32 s66, 3
    s_cselect_b32 s67, -1376256, s68
    v_add_u32 v4, s67, v4
    s_waitcnt vmcnt(0)
    global_load_dwordx4 v[92:95], v4, s[6:7] offset:0 nt
    global_load_dwordx4 v[96:99], v4, s[6:7] offset:256 nt
    global_load_dwordx4 v[100:103], v4, s[6:7] offset:512 nt
    s_cmp_eq_u32 s66, 2
    s_cselect_b32 s67, -1376256, s68
    v_add_u32 v4, s67, v4
    s_waitcnt vmcnt(0)
    global_load_dwordx4 v[104:107], v4, s[6:7] offset:0 nt
    global_load_dwordx4 v[108:111], v4, s[6:7] offset:256 nt
    global_load_dwordx4 v[112:115], v4, s[6:7] offset:512 nt
    s_cmp_eq_u32 s66, 1
    s_cselect_b32 s67, -1376256, s68
    v_add_u32 v4, s67, v4
    s_waitcnt vmcnt(0)
    global_load_dwordx4 v[116:119], v4, s[6:7] offset:0 nt
    global_load_dwordx4 v[120:123], v4, s[6:7] offset:256 nt
    global_load_dwordx4 v[124:127], v4, s[6:7] offset:512 nt
L_vphase:
    s_waitcnt vmcnt(0)
    global_load_dwordx4 v[128:131], v8, s[8:9] offset:0 nt
    global_load_dwordx4 v[132:135], v8, s[8:9] offset:256 nt
    global_load_dwordx4 v[136:139], v8, s[8:9] offset:512 nt
    s_cmp_eq_u32 s66, 7
    s_cselect_b32 s67, -1376256, s68
    v_add_u32 v8, s67, v8
    s_mov_b32 s46, 0
L_qspin:
    ds_read_b32 v27, v11 offset:0
    ds_read_b128 v[224:227], v28
    ds_read_b128 v[228:231], v29
    ds_read_b128 v[232:235], v30
    s_add_u32 s46, s46, 1
    s_waitcnt lgkmcnt(0)
    v_readfirstlane_b32 s37, v27
    s_cmp_lg_u32 s37, 0
    s_cbranch_scc1 L_qgot
    s_sleep 2
    s_cmp_lt_u32 s46, 1048576
    s_cbranch_scc1 L_qspin
L_qgot:
    v_mfma_f32_16x16x32_bf16 v[236:239], v[32:35], v[224:227], 0
    v_mfma_f32_16x16x32_bf16 v[236:239], v[36:39], v[228:231], v[236:239]
    v_mfma_f32_16x16x32_bf16 v[236:239], v[40:43], v[232:235], v[236:239]
    v_mfma_f32_16x16x32_bf16 v[32:35], v[44:47], v[224:227], 0
    v_mfma_f32_16x16x32_bf16 v[32:35], v[48:51], v[228:231], v[32:35]
    v_mfma_f32_16x16x32_bf16 v[32:35], v[52:55], v[232:235], v[32:35]
    v_mfma_f32_16x16x32_bf16 v[44:47], v[56:59], v[224:227], 0
    v_mfma_f32_16x16x32_bf16 v[44:47], v[60:63], v[228:231], v[44:47]
    v_mfma_f32_16x16x32_bf16 v[44:47], v[64:67], v[232:235], v[44:47]
    v_mfma_f32_16x16x32_bf16 v[56:59], v[68:71], v[224:227], 0
    v_mfma_f32_16x16x32_bf16 v[56:59], v[72:75], v[228:231], v[56:59]
    v_mfma_f32_16x16x32_bf16 v[56:59], v[76:79], v[232:235], v[56:59]
    v_mfma_f32_16x16x32_bf16 v[68:71], v[80:83], v[224:227], 0
    v_mfma_f32_16x16x32_bf16 v[68:71], v[84:87], v[228:231], v[68:71]
    v_mfma_f32_16x16x32_bf16 v[68:71], v[88:91], v[232:235], v[68:71]
    v_mfma_f32_16x16x32_bf16 v[80:83], v[92:95], v[224:227], 0
    v_mfma_f32_16x16x32_bf16 v[80:83], v[96:99], v[228:231], v[80:83]
    v_mfma_f32_16x16x32_bf16 v[80:83], v[100:103], v[232:235], v[80:83]
    v_mfma_f32_16x16x32_bf16 v[92:95], v[104:107], v[224:227], 0
    v_mfma_f32_16x16x32_bf16 v[92:95], v[108:111], v[228:231], v[92:95]
    v_mfma_f32_16x16x32_bf16 v[92:95], v[112:115], v[232:235], v[92:95]
    v_mfma_f32_16x16x32_bf16 v[104:107], v[116:119], v[224:227], 0
    v_mfma_f32_16x16x32_bf16 v[104:107], v[120:123], v[228:231], v[104:107]
    v_mfma_f32_16x16x32_bf16 v[104:107], v[124:127], v[232:235], v[104:107]
    v_mov_b32_dpp v16, v236 quad_perm:[0,0,0,0] row_mask:0xf bank_mask:0xf
    v_mov_b32_dpp v17, v32 quad_perm:[0,0,0,0] row_mask:0xf bank_mask:0xf
    v_mov_b32_dpp v18, v44 quad_perm:[0,0,0,0] row_mask:0xf bank_mask:0xf
    v_mov_b32_dpp v19, v56 quad_perm:[0,0,0,0] row_mask:0xf bank_mask:0xf
    v_mov_b32_dpp v20, v68 quad_perm:[0,0,0,0] row_mask:0xf bank_mask:0xf
    v_mov_b32_dpp v21, v80 quad_perm:[0,0,0,0] row_mask:0xf bank_mask:0xf
    v_mov_b32_dpp v22, v92 quad_perm:[0,0,0,0] row_mask:0xf bank_mask:0xf
    s_nop 0
    v_mov_b32_dpp v23, v104 quad_perm:[0,0,0,0] row_mask:0xf bank_mask:0xf
    v_add_f32_dpp v16, v237, v16 quad_perm:[1,1,1,1] row_mask:0xf bank_mask:0xf
    v_add_f32_dpp v17, v33, v17 quad_perm:[1,1,1,1] row_mask:0xf bank_mask:0xf
    v_add_f32_dpp v18, v45, v18 quad_perm:[1,1,1,1] row_mask:0xf bank_mask:0xf
    v_add_f32_dpp v19, v57, v19 quad_perm:[1,1,1,1] row_mask:0xf bank_mask:0xf
    v_add_f32_dpp v20, v69, v20 quad_perm:[1,1,1,1] row_mask:0xf bank_mask:0xf
    v_add_f32_dpp v21, v81, v21 quad_perm:[1,1,1,1] row_mask:0xf bank_mask:0xf
    v_add_f32_dpp v22, v93, v22 quad_perm:[1,1,1,1] row_mask:0xf bank_mask:0xf
    v_add_f32_dpp v23, v105, v23 quad_perm:[1,1,1,1] row_mask:0xf bank_mask:0xf
    v_add_f32_dpp v16, v238, v16 quad_perm:[2,2,2,2] row_mask:0xf bank_mask:0xf
    v_add_f32_dpp v17, v34, v17 quad_perm:[2,2,2,2] row_mask:0xf bank_mask:0xf
    v_add_f32_dpp v18, v46, v18 quad_perm:[2,2,2,2] row_mask:0xf bank_mask:0xf
    v_add_f32_dpp v19, v58, v19 quad_perm:[2,2,2,2] row_mask:0xf bank_mask:0xf
    v_add_f32_dpp v20, v70, v20 quad_perm:[2,2,2,2] row_mask:0xf bank_mask:0xf
    v_add_f32_dpp v21, v82, v21 quad_perm:[2,2,2,2] row_mask:0xf bank_mask:0xf
    v_add_f32_dpp v22, v94, v22 quad_perm:[2,2,2,2] row_mask:0xf bank_mask:0xf
    v_add_f32_dpp v23, v106, v23 quad_perm:[2,2,2,2] row_mask:0xf bank_mask:0xf
    v_add_f32_dpp v16, v239, v16 quad_perm:[3,3,3,3] row_mask:0xf bank_mask:0xf
    v_add_f32_dpp v17, v35, v17 quad_perm:[3,3,3,3] row_mask:0xf bank_mask:0xf
    v_add_f32_dpp v18, v47, v18 quad_perm:[3,3,3,3] row_mask:0xf bank_mask:0xf
    v_add_f32_dpp v19, v59, v19 quad_perm:[3,3,3,3] row_mask:0xf bank_mask:0xf
    v_add_f32_dpp v20, v71, v20 quad_perm:[3,3,3,3] row_mask:0xf bank_mask:0xf
    v_add_f32_dpp v21, v83, v21 quad_perm:[3,3,3,3] row_mask:0xf bank_mask:0xf
    v_add_f32_dpp v22, v95, v22 quad_perm:[3,3,3,3] row_mask:0xf bank_mask:0xf
    v_add_f32_dpp v23, v107, v23 quad_perm:[3,3,3,3] row_mask:0xf bank_mask:0xf
    s_mov_b32 s34, 0x3d93cd3a
    s_mov_b32 s35, 0xffff0000
    v_cvt_pk_bf16_f32 v24, v16, v17
    v_cvt_pk_bf16_f32 v25, v18, v19
    v_cvt_pk_bf16_f32 v26, v20, v21
    s_waitcnt vmcnt(0)
    global_load_dwordx4 v[140:143], v8, s[8:9] offset:0 nt
    global_load_dwordx4 v[144:147], v8, s[8:9] offset:256 nt
    global_load_dwordx4 v[148:151], v8, s[8:9] offset:512 nt
    s_cmp_eq_u32 s66, 6
    s_cselect_b32 s67, -1376256, s68
    v_add_u32 v8, s67, v8
    v_cvt_pk_bf16_f32 v27, v22, v23
    v_lshlrev_b32 v16, 16, v24
    v_and_b32 v17, s35, v24
    v_lshlrev_b32 v18, 16, v25
    v_and_b32 v19, s35, v25
    v_lshlrev_b32 v20, 16, v26
    v_and_b32 v21, s35, v26
    v_lshlrev_b32 v22, 16, v27
    v_and_b32 v23, s35, v27
    v_mul_f32 v16, s34, v16
    v_mul_f32 v17, s34, v17
    v_mul_f32 v18, s34, v18
    v_mul_f32 v19, s34, v19
    v_mul_f32 v20, s34, v20
    v_mul_f32 v21, s34, v21
    v_mul_f32 v22, s34, v22
    v_mul_f32 v23, s34, v23
    v_cvt_pk_bf16_f32 v24, v16, v17
    v_cvt_pk_bf16_f32 v25, v18, v19
    v_cvt_pk_bf16_f32 v26, v20, v21
    v_cvt_pk_bf16_f32 v27, v22, v23
    v_lshlrev_b32 v16, 16, v24
    v_and_b32 v17, s35, v24
    v_lshlrev_b32 v18, 16, v25
    v_and_b32 v19, s35, v25
    v_lshlrev_b32 v20, 16, v26
    v_and_b32 v21, s35, v26
    v_lshlrev_b32 v22, 16, v27
    v_and_b32 v23, s35, v27
    v_max3_f32 v24, v16, v17, v18
    v_max3_f32 v25, v19, v20, v21
    v_max3_f32 v24, v24, v22, v23
    v_max_f32 v24, v24, v25
    s_nop 1
    v_max_f32_dpp v24, v24, v24 row_ror:8 row_mask:0xf bank_mask:0xf
    s_nop 1
    v_max_f32_dpp v24, v24, v24 row_bcast:15 row_mask:0xa bank_mask:0xf
    s_nop 1
    v_max_f32_dpp v24, v24, v24 row_bcast:31 row_mask:0xc bank_mask:0xf
    s_nop 0
    v_readlane_b32 s38, v24, 63
    s_nop 1
    v_subrev_f32 v16, s38, v16
    v_subrev_f32 v17, s38, v17
    v_subrev_f32 v18, s38, v18
    v_subrev_f32 v19, s38, v19
    v_subrev_f32 v20, s38, v20
    v_subrev_f32 v21, s38, v21
    v_subrev_f32 v22, s38, v22
    v_subrev_f32 v23, s38, v23
    v_mul_f32 v16, 0x3fb8aa3b, v16
    v_mul_f32 v17, 0x3fb8aa3b, v17
    v_mul_f32 v18, 0x3fb8aa3b, v18
    v_mul_f32 v19, 0x3fb8aa3b, v19
    v_mul_f32 v20, 0x3fb8aa3b, v20
    v_mul_f32 v21, 0x3fb8aa3b, v21
    v_mul_f32 v22, 0x3fb8aa3b, v22
    v_mul_f32 v23, 0x3fb8aa3b, v23
    v_exp_f32 v16, v16
    v_exp_f32 v17, v17
    v_exp_f32 v18, v18
    v_exp_f32 v19, v19
    v_exp_f32 v20, v20
    v_exp_f32 v21, v21
    v_exp_f32 v22, v22
    v_exp_f32 v23, v23
    v_cvt_pk_bf16_f32 v240, v16, v16
    v_cvt_pk_bf16_f32 v241, v17, v17
    v_cvt_pk_bf16_f32 v242, v18, v18
    v_cvt_pk_bf16_f32 v243, v19, v19
    v_cvt_pk_bf16_f32 v244, v20, v20
    v_cvt_pk_bf16_f32 v245, v21, v21
    v_cvt_pk_bf16_f32 v246, v22, v22
    v_cvt_pk_bf16_f32 v247, v23, v23
    v_add_f32 v24, v16, v17
    v_add_f32 v25, v18, v19
    v_add_f32 v26, v20, v21
    v_add_f32 v27, v22, v23
    v_add_f32 v24, v24, v25
    v_add_f32 v26, v26, v27
    v_add_f32 v24, v24, v26
    s_nop 1
    v_add_f32_dpp v24, v24, v24 row_ror:8 row_mask:0xf bank_mask:0xf
    s_nop 1
    v_add_f32_dpp v24, v24, v24 row_bcast:15 row_mask:0xa bank_mask:0xf
    s_nop 1
    v_add_f32_dpp v24, v24, v24 row_bcast:31 row_mask:0xc bank_mask:0xf
    s_nop 0
    v_readlane_b32 s39, v24, 63
    v_and_b32 v32, v12, v240
    v_and_b32 v33, v13, v240
    v_and_b32 v34, v14, v240
    v_and_b32 v35, v15, v240
    v_and_b32 v36, v12, v241
    v_and_b32 v37, v13, v241
    v_and_b32 v38, v14, v241
    v_and_b32 v39, v15, v241
    v_and_b32 v40, v12, v242
    v_and_b32 v41, v13, v242
    v_and_b32 v42, v14, v242
    v_and_b32 v43, v15, v242
    v_and_b32 v44, v12, v243
    v_and_b32 v45, v13, v243
    v_and_b32 v46, v14, v243
    v_and_b32 v47, v15, v243
    v_and_b32 v48, v12, v244
    v_and_b32 v49, v13, v244
    v_and_b32 v50, v14, v244
    v_and_b32 v51, v15, v244
    v_and_b32 v52, v12, v245
    v_and_b32 v53, v13, v245
    v_and_b32 v54, v14, v245
    v_and_b32 v55, v15, v245
    v_and_b32 v56, v12, v246
    v_and_b32 v57, v13, v246
    v_and_b32 v58, v14, v246
    v_and_b32 v59, v15, v246
    v_and_b32 v60, v12, v247
    v_and_b32 v61, v13, v247
    v_and_b32 v62, v14, v247
    v_and_b32 v63, v15, v247
    v_mov_b32 v24, s38
    v_mov_b32 v25, s39
    s_lshl_b32 s34, s26, 3
    v_mov_b32 v26, s34
    v_mov_b32 v23, 1
    s_mov_b64 exec, 1
    ds_write_b64 v26, v[24:25] offset:64
    ds_add_u32 v11, v23 offset:4
    s_mov_b64 exec, -1
    s_mul_i32 s34, s26, 1536
    v_and_b32 v27, 7, v0
    v_lshlrev_b32 v27, 4, v27
    v_lshl_add_u32 v27, v3, 7, v27
    v_add_u32 v27, s34, v27
    s_waitcnt vmcnt(0)
    global_load_dwordx4 v[152:155], v8, s[8:9] offset:0 nt
    global_load_dwordx4 v[156:159], v8, s[8:9] offset:256 nt
    global_load_dwordx4 v[160:163], v8, s[8:9] offset:512 nt
    s_cmp_eq_u32 s66, 5
    s_cselect_b32 s67, -1376256, s68
    v_add_u32 v8, s67, v8
    v_mfma_f32_16x16x32_bf16 v[64:67], v[128:131], v[32:35], 0
    v_mfma_f32_16x16x32_bf16 v[68:71], v[132:135], v[32:35], 0
    v_mfma_f32_16x16x32_bf16 v[72:75], v[136:139], v[32:35], 0
    v_mfma_f32_16x16x32_bf16 v[64:67], v[140:143], v[36:39], v[64:67]
    v_mfma_f32_16x16x32_bf16 v[68:71], v[144:147], v[36:39], v[68:71]
    v_mfma_f32_16x16x32_bf16 v[72:75], v[148:151], v[36:39], v[72:75]
    s_waitcnt vmcnt(0)
    global_load_dwordx4 v[164:167], v8, s[8:9] offset:0 nt
    global_load_dwordx4 v[168:171], v8, s[8:9] offset:256 nt
    global_load_dwordx4 v[172:175], v8, s[8:9] offset:512 nt
    s_cmp_eq_u32 s66, 4
    s_cselect_b32 s67, -1376256, s68
    v_add_u32 v8, s67, v8
    s_cmp_lg_u32 s26, 7
    s_cbranch_scc1 L_nogf
    v_and_b32 v16, 7, v0
    v_lshlrev_b32 v16, 7, v16
    v_add_u32 v16, 4096, v16
    global_load_dword v17, v16, s[24:25] sc1
L_nogf:
    v_mfma_f32_16x16x32_bf16 v[64:67], v[152:155], v[40:43], v[64:67]
    v_mfma_f32_16x16x32_bf16 v[68:71], v[156:159], v[40:43], v[68:71]
    v_mfma_f32_16x16x32_bf16 v[72:75], v[160:163], v[40:43], v[72:75]
    s_cmp_eq_u32 s26, 7
    s_cbranch_scc1 L_gfstep
    s_waitcnt vmcnt(0)
    global_load_dwordx4 v[176:179], v8, s[8:9] offset:0 nt
    global_load_dwordx4 v[180:183], v8, s[8:9] offset:256 nt
    global_load_dwordx4 v[184:187], v8, s[8:9] offset:512 nt
    s_cmp_eq_u32 s66, 3
    s_cselect_b32 s67, -1376256, s68
    v_add_u32 v8, s67, v8
L_gfback:
    v_mfma_f32_16x16x32_bf16 v[64:67], v[164:167], v[44:47], v[64:67]
    v_mfma_f32_16x16x32_bf16 v[68:71], v[168:171], v[44:47], v[68:71]
    v_mfma_f32_16x16x32_bf16 v[72:75], v[172:175], v[44:47], v[72:75]
    s_waitcnt vmcnt(0)
    global_load_dwordx4 v[188:191], v8, s[8:9] offset:0 nt
    global_load_dwordx4 v[192:195], v8, s[8:9] offset:256 nt
    global_load_dwordx4 v[196:199], v8, s[8:9] offset:512 nt
    s_cmp_eq_u32 s66, 2
    s_cselect_b32 s67, -1376256, s68
    v_add_u32 v8, s67, v8
    v_mfma_f32_16x16x32_bf16 v[64:67], v[176:179], v[48:51], v[64:67]
    v_mfma_f32_16x16x32_bf16 v[68:71], v[180:183], v[48:51], v[68:71]
    v_mfma_f32_16x16x32_bf16 v[72:75], v[184:187], v[48:51], v[72:75]
    s_waitcnt vmcnt(0)
    global_load_dwordx4 v[200:203], v8, s[8:9] offset:0 nt
    global_load_dwordx4 v[204:207], v8, s[8:9] offset:256 nt
    global_load_dwordx4 v[208:211], v8, s[8:9] offset:512 nt
    s_cmp_eq_u32 s66, 1
    s_cselect_b32 s67, -1376256, s68
    v_add_u32 v8, s67, v8
    v_mfma_f32_16x16x32_bf16 v[64:67], v[188:191], v[52:55], v[64:67]
    v_mfma_f32_16x16x32_bf16 v[68:71], v[192:195], v[52:55], v[68:71]
    v_mfma_f32_16x16x32_bf16 v[72:75], v[196:199], v[52:55], v[72:75]
    s_mov_b32 s46, 0
L_kspin:
    ds_read_b32 v25, v11 offset:8
    s_add_u32 s46, s46, 1
    s_waitcnt lgkmcnt(0)
    v_readfirstlane_b32 s37, v25
    s_cmp_lg_u32 s37, 0
    s_cbranch_scc1 L_kspin_x
    s_sleep 1
    s_cmp_lt_u32 s46, 1048576
    s_cbranch_scc1 L_kspin
L_kspin_x:
    s_and_b32 s52, s26, 3
    s_mul_i32 s65, s27, 36864
    s_sub_u32 s53, s28, 20
    s_mul_i32 s31, s27, 12
    s_add_u32 s31, s31, s28
    s_mov_b64 s[32:33], s[16:17]
    v_mov_b32 v248, 0
    v_mov_b32 v249, 0
    v_mov_b32 v250, 0
    v_mov_b32 v251, 0
    v_mov_b32 v252, 0
    v_mov_b32 v254, 0
    s_cmp_ge_u32 s26, 4
    s_cbranch_scc1 L_s_setup
    s_cmp_lt_u32 s28, 20
    s_cbranch_scc0 L_fs_setup
    v_lshrrev_b32 v31, 3, v0
    v_and_b32 v24, 6, v31
    v_and_b32 v25, 7, v0
    v_xor_b32 v24, v24, v25
    v_mul_u32_u24 v31, 1280, v31
    v_lshl_add_u32 v31, v24, 4, v31
    s_cmp_ge_u32 s28, 10
    s_cselect_b32 s56, 1, 0
    s_mul_i32 s57, s56, 10
    s_sub_u32 s57, s28, s57
    s_mul_i32 s34, s27, 768
    s_mul_i32 s35, s56, 384
    s_add_u32 s34, s34, s35
    s_mul_i32 s35, s52, 96
    s_add_u32 s34, s34, s35
    s_mul_i32 s34, s34, 1280
    s_lshl_b32 s35, s57, 7
    s_add_u32 s34, s34, s35
    s_add_u32 s32, s12, s34
    s_addc_u32 s33, s13, 0
    s_mul_i32 s49, s52, 12288
    s_add_u32 s49, s49, 20480
    s_lshr_b32 s34, s52, 1
    s_lshl1_add_u32 s34, s56, s34
    s_lshl_b32 s34, s34, 12
    s_add_u32 s34, s34, s65
    s_add_u32 s34, s34, 851968
    s_and_b32 s35, s52, 1
    s_mul_i32 s35, s35, 1536
    s_add_u32 s35, s35, s34
    v_and_b32 v24, 7, v0
    v_lshlrev_b32 v24, 4, v24
    v_lshl_add_u32 v24, v3, 7, v24
    v_add_u32 v224, s35, v24
    v_lshl_add_u32 v25, v3, 2, v2
    v_and_b32 v25, 7, v25
    v_lshl_add_u32 v225, v25, 3, s34
    v_lshrrev_b32 v26, 1, v3
    v_lshlrev_b32 v26, 4, v26
    v_and_b32 v24, 1, v3
    v_lshl_add_u32 v26, v24, 2, v26
    v_lshrrev_b32 v28, 2, v2
    v_add_u32 v26, v26, v28
    v_bfe_u32 v28, v26, 1, 2
    v_lshlrev_b32 v26, 7, v26
    v_and_b32 v24, 3, v0
    v_lshl_add_u32 v26, v24, 3, v26
    v_add_u32 v26, s49, v26
    v_xor_b32 v24, 0, v28
    v_lshl_add_u32 v226, v24, 5, v26
    v_xor_b32 v24, 1, v28
    v_lshl_add_u32 v227, v24, 5, v26
    v_xor_b32 v24, 2, v28
    v_lshl_add_u32 v228, v24, 5, v26
    v_xor_b32 v24, 3, v28
    v_lshl_add_u32 v229, v24, 5, v26
    v_and_b32 v24, 1, v3
    v_lshlrev_b32 v24, 7, v24
    v_lshrrev_b32 v25, 1, v3
    v_lshl_add_u32 v24, v25, 6, v24
    v_lshl_add_u32 v24, v2, 2, v24
    s_lshl_b32 s34, s52, 8
    v_add_u32 v230, s34, v24
    v_lshlrev_b32 v231, 2, v0
    v_add_u32 v231, 4096, v231
    s_mul_i32 s34, s27, 5120
    s_lshl_b32 s35, s28, 8
    s_add_u32 s34, s34, s35
    s_add_u32 s34, s34, 524288
    v_lshl_add_u32 v233, v0, 2, s34
    v_cmp_gt_u32 s[54:55], 32, v0
    s_waitcnt vmcnt(0)
    global_load_dwordx4 v[212:215], v8, s[8:9] offset:0 nt
    global_load_dwordx4 v[216:219], v8, s[8:9] offset:256 nt
    global_load_dwordx4 v[220:223], v8, s[8:9] offset:512 nt
    s_mov_b32 m0, s49
    s_add_u32 s49, s49, 1024
    global_load_lds_dwordx4 v31, s[32:33] nt
    s_add_u32 s32, s32, 10240
    s_addc_u32 s33, s33, 0
    v_mfma_f32_16x16x32_bf16 v[64:67], v[200:203], v[56:59], v[64:67]
    v_mfma_f32_16x16x32_bf16 v[68:71], v[204:207], v[56:59], v[68:71]
    v_mfma_f32_16x16x32_bf16 v[72:75], v[208:211], v[56:59], v[72:75]
    s_waitcnt vmcnt(3)
    v_mfma_f32_16x16x32_bf16 v[64:67], v[212:215], v[60:63], v[64:67]
    s_waitcnt vmcnt(2)
    v_mfma_f32_16x16x32_bf16 v[68:71], v[216:219], v[60:63], v[68:71]
    s_waitcnt vmcnt(1)
    v_mfma_f32_16x16x32_bf16 v[72:75], v[220:223], v[60:63], v[72:75]
    s_mov_b32 m0, s49
    s_add_u32 s49, s49, 1024
    global_load_lds_dwordx4 v31, s[32:33] nt
    s_add_u32 s32, s32, 10240
    s_addc_u32 s33, s33, 0
    s_mov_b32 m0, s49
    s_add_u32 s49, s49, 1024
    global_load_lds_dwordx4 v31, s[32:33] nt
    s_add_u32 s32, s32, 10240
    s_addc_u32 s33, s33, 0
    s_mov_b64 exec, s[40:41]
    ds_write_b128 v27, v[64:67] offset:8192
    s_mov_b64 exec, s[42:43]
    ds_write_b128 v27, v[68:71] offset:8704
    s_mov_b64 exec, s[44:45]
    ds_write_b128 v27, v[72:75] offset:9216
    s_mov_b64 exec, -1
    s_mov_b32 m0, s49
    s_add_u32 s49, s49, 1024
    global_load_lds_dwordx4 v31, s[32:33] nt
    s_add_u32 s32, s32, 10240
    s_addc_u32 s33, s33, 0
    s_mov_b32 m0, s49
    s_add_u32 s49, s49, 1024
    global_load_lds_dwordx4 v31, s[32:33] nt
    s_add_u32 s32, s32, 10240
    s_addc_u32 s33, s33, 0
    s_mov_b32 m0, s49
    s_add_u32 s49, s49, 1024
    global_load_lds_dwordx4 v31, s[32:33] nt
    s_add_u32 s32, s32, 10240
    s_addc_u32 s33, s33, 0
    s_waitcnt lgkmcnt(0)
    s_barrier
    s_barrier
    s_mov_b32 m0, s49
    s_add_u32 s49, s49, 1024
    global_load_lds_dwordx4 v31, s[32:33] nt
    s_add_u32 s32, s32, 10240
    s_addc_u32 s33, s33, 0
    s_mov_b32 m0, s49
    s_add_u32 s49, s49, 1024
    global_load_lds_dwordx4 v31, s[32:33] nt
    s_add_u32 s32, s32, 10240
    s_addc_u32 s33, s33, 0
    s_mov_b32 m0, s49
    s_add_u32 s49, s49, 1024
    global_load_lds_dwordx4 v31, s[32:33] nt
    s_add_u32 s32, s32, 10240
    s_addc_u32 s33, s33, 0
    s_mov_b32 m0, s49
    s_add_u32 s49, s49, 1024
    global_load_lds_dwordx4 v31, s[32:33] nt
    s_add_u32 s32, s32, 10240
    s_addc_u32 s33, s33, 0
    s_mov_b32 m0, s49
    s_add_u32 s49, s49, 1024
    global_load_lds_dwordx4 v31, s[32:33] nt
    s_add_u32 s32, s32, 10240
    s_addc_u32 s33, s33, 0
    s_mov_b32 m0, s49
    s_add_u32 s49, s49, 1024
    global_load_lds_dwordx4 v31, s[32:33] nt
    s_add_u32 s32, s32, 10240
    s_addc_u32 s33, s33, 0
    s_waitcnt vmcnt(8)
    ds_read_b64_tr_b16 v[48:49], v226 offset:0
    ds_read_b64_tr_b16 v[50:51], v226 offset:1024
    ds_read_b64_tr_b16 v[60:61], v227 offset:0
    ds_read_b64_tr_b16 v[62:63], v227 offset:1024
    ds_read_b64_tr_b16 v[72:73], v228 offset:0
    ds_read_b64_tr_b16 v[74:75], v228 offset:1024
    ds_read_b64_tr_b16 v[84:85], v229 offset:0
    ds_read_b64_tr_b16 v[86:87], v229 offset:1024
    s_waitcnt vmcnt(8)
    global_load_dwordx4 v[32:35], v224, s[24:25] sc1
    global_load_dwordx4 v[36:39], v224, s[24:25] offset:512 sc1
    global_load_dwordx4 v[40:43], v224, s[24:25] offset:1024 sc1
    global_load_dwordx2 v[44:45], v225, s[24:25] offset:3072 sc1
    s_waitcnt vmcnt(8)
    ds_read_b64_tr_b16 v[52:53], v226 offset:4096
    ds_read_b64_tr_b16 v[54:55], v226 offset:5120
    ds_read_b64_tr_b16 v[64:65], v227 offset:4096
    ds_read_b64_tr_b16 v[66:67], v227 offset:5120
    ds_read_b64_tr_b16 v[76:77], v228 offset:4096
    ds_read_b64_tr_b16 v[78:79], v228 offset:5120
    ds_read_b64_tr_b16 v[88:89], v229 offset:4096
    ds_read_b64_tr_b16 v[90:91], v229 offset:5120
    s_waitcnt vmcnt(4)
    ds_read_b64_tr_b16 v[56:57], v226 offset:8192
    ds_read_b64_tr_b16 v[58:59], v226 offset:9216
    ds_read_b64_tr_b16 v[68:69], v227 offset:8192
    ds_read_b64_tr_b16 v[70:71], v227 offset:9216
    ds_read_b64_tr_b16 v[80:81], v228 offset:8192
    ds_read_b64_tr_b16 v[82:83], v228 offset:9216
    ds_read_b64_tr_b16 v[92:93], v229 offset:8192
    ds_read_b64_tr_b16 v[94:95], v229 offset:9216
    s_mov_b32 s46, 0
    s_waitcnt vmcnt(0)
L_ochk:
    v_max3_u32 v16, v32, v33, v34
    v_max3_u32 v17, v35, v36, v37
    v_max3_u32 v16, v16, v38, v39
    v_max3_u32 v17, v17, v40, v41
    v_max3_u32 v16, v16, v42, v43
    v_max3_u32 v17, v17, v44, v45
    v_max_u32 v16, v16, v17
    v_cmp_eq_u32 vcc, -1, v16
    s_cbranch_vccnz L_opoll
L_ogot:
    s_waitcnt lgkmcnt(0)
    v_mfma_f32_16x16x32_bf16 v[100:103], v[32:35], v[48:51], 0
    v_max_f32_dpp v16, v44, v44 row_ror:1 row_mask:0xf bank_mask:0xf
    v_mfma_f32_16x16x32_bf16 v[104:107], v[32:35], v[60:63], 0
    v_mfma_f32_16x16x32_bf16 v[100:103], v[36:39], v[52:55], v[100:103]
    v_max_f32_dpp v16, v16, v16 row_ror:2 row_mask:0xf bank_mask:0xf
    v_mfma_f32_16x16x32_bf16 v[104:107], v[36:39], v[64:67], v[104:107]
    v_mfma_f32_16x16x32_bf16 v[100:103], v[40:43], v[56:59], v[100:103]
    v_max_f32_dpp v16, v16, v16 row_ror:4 row_mask:0xf bank_mask:0xf
    v_mfma_f32_16x16x32_bf16 v[104:107], v[40:43], v[68:71], v[104:107]
    v_sub_f32 v16, v44, v16
    v_mul_f32 v16, 0x3fb8aa3b, v16
    v_mfma_f32_16x16x32_bf16 v[108:111], v[32:35], v[72:75], 0
    v_exp_f32 v16, v16
    v_mfma_f32_16x16x32_bf16 v[112:115], v[32:35], v[84:87], 0
    v_mul_f32 v17, v16, v45
    v_mfma_f32_16x16x32_bf16 v[108:111], v[36:39], v[76:79], v[108:111]
    v_mul_f32_dpp v18, v16, v100 row_newbcast:0 row_mask:0xf bank_mask:0xf
    v_add_f32_dpp v17, v17, v17 row_ror:1 row_mask:0xf bank_mask:0xf
    v_mfma_f32_16x16x32_bf16 v[112:115], v[36:39], v[88:91], v[112:115]
    v_mul_f32_dpp v19, v16, v104 row_newbcast:0 row_mask:0xf bank_mask:0xf
    v_fmac_f32_dpp v18, v16, v101 row_newbcast:1 row_mask:0xf bank_mask:0xf
    v_mfma_f32_16x16x32_bf16 v[108:111], v[40:43], v[80:83], v[108:111]
    v_add_f32_dpp v17, v17, v17 row_ror:2 row_mask:0xf bank_mask:0xf
    v_fmac_f32_dpp v19, v16, v105 row_newbcast:1 row_mask:0xf bank_mask:0xf
    v_mfma_f32_16x16x32_bf16 v[112:115], v[40:43], v[92:95], v[112:115]
    v_fmac_f32_dpp v18, v16, v102 row_newbcast:2 row_mask:0xf bank_mask:0xf
    v_add_f32_dpp v17, v17, v17 row_ror:4 row_mask:0xf bank_mask:0xf
    v_fmac_f32_dpp v19, v16, v106 row_newbcast:2 row_mask:0xf bank_mask:0xf
    v_fmac_f32_dpp v18, v16, v103 row_newbcast:3 row_mask:0xf bank_mask:0xf
    v_rcp_f32 v17, v17
    v_fmac_f32_dpp v19, v16, v107 row_newbcast:3 row_mask:0xf bank_mask:0xf
    v_cndmask_b32 v18, v19, v18, s[54:55]
    v_mul_f32_dpp v20, v16, v108 row_newbcast:0 row_mask:0xf bank_mask:0xf
    v_mul_f32_dpp v21, v16, v112 row_newbcast:0 row_mask:0xf bank_mask:0xf
    s_nop 0
    v_fmac_f32_dpp v20, v16, v109 row_newbcast:1 row_mask:0xf bank_mask:0xf
    v_fmac_f32_dpp v21, v16, v113 row_newbcast:1 row_mask:0xf bank_mask:0xf
    s_nop 0
    v_fmac_f32_dpp v20, v16, v110 row_newbcast:2 row_mask:0xf bank_mask:0xf
    v_fmac_f32_dpp v21, v16, v114 row_newbcast:2 row_mask:0xf bank_mask:0xf
    s_nop 0
    v_fmac_f32_dpp v20, v16, v111 row_newbcast:3 row_mask:0xf bank_mask:0xf
    v_fmac_f32_dpp v21, v16, v115 row_newbcast:3 row_mask:0xf bank_mask:0xf
    v_cndmask_b32 v20, v21, v20, s[54:55]
    s_cmp_lg_u32 s26, 0
    s_nop 0
    v_permlane16_swap_b32 v18, v20
    v_add_f32 v18, v18, v20
    v_mul_f32 v18, v18, v17
    ds_write_b32 v230, v18 offset:4096
    s_waitcnt lgkmcnt(0)
    s_barrier
    s_cbranch_scc1 L_y_done
    ds_read2st64_b32 v[32:33], v231 offset0:0 offset1:1
    ds_read2st64_b32 v[34:35], v231 offset0:2 offset1:3
    s_waitcnt lgkmcnt(0)
    v_pk_add_f32 v[32:33], v[32:33], v[34:35]
    v_add_f32 v32, v32, v33
    global_store_dword v233, v32, s[24:25] sc1
L_y_done:
    s_barrier
    s_branch L_fin
L_opoll:
    s_mov_b64 exec, vcc
    global_load_dwordx4 v[32:35], v224, s[24:25] sc1
    global_load_dwordx4 v[36:39], v224, s[24:25] offset:512 sc1
    global_load_dwordx4 v[40:43], v224, s[24:25] offset:1024 sc1
    global_load_dwordx2 v[44:45], v225, s[24:25] offset:3072 sc1
    s_mov_b64 exec, -1
    s_add_u32 s46, s46, 1
    s_cmp_lt_u32 s46, 131072
    s_waitcnt vmcnt(0)
    s_cbranch_scc1 L_ochk
    s_branch L_ogot
L_fs_setup:
    v_lshrrev_b32 v31, 3, v0
    v_and_b32 v24, 6, v31
    v_and_b32 v25, 7, v0
    v_xor_b32 v24, v24, v25
    v_mul_u32_u24 v31, 1280, v31
    v_lshl_add_u32 v31, v24, 4, v31
    s_min_u32 s56, s53, 9
    v_and_b32 v24, 3, v0
    v_lshl_add_u32 v24, v3, 2, v24
    s_lshl_b32 s34, s56, 7
    v_lshl_add_u32 v25, v24, 3, s34
    v_lshrrev_b32 v26, 3, v2
    v_lshl_add_u32 v29, v26, 2, v25
    global_load_dword v116, v29, s[4:5]
    s_add_u32 s35, s65, 883712
    v_add_u32 v239, s35, v29
    v_lshlrev_b32 v23, 2, v24
    v_lshl_add_u32 v23, v26, 6, v23
    v_lshlrev_b32 v22, 4, v3
    v_lshrrev_b32 v26, 2, v2
    v_mul_u32_u24 v26, 2560, v26
    v_lshl_add_u32 v26, v25, 1, v26
    v_add_u32 v233, 524288, v26
    v_add_u32 v234, 10240, v233
    v_add_u32 v235, 20480, v233
    v_add_u32 v236, 30720, v233
    v_lshrrev_b32 v30, 3, v0
    v_mul_u32_u24 v30, 1792, v30
    v_add_u32 v30, v30, v31
    s_lshl2_add_u32 s34, s56, s52
    s_mul_i32 s34, s34, 49152
    s_mul_i32 s35, s27, 384
    s_add_u32 s34, s34, s35
    s_add_u32 s32, s16, s34
    s_addc_u32 s33, s17, 0
    s_mul_i32 s49, s52, 6144
    s_add_u32 s49, s49, 20480
    v_bfe_u32 v28, v0, 3, 1
    v_bfe_u32 v26, v0, 2, 1
    v_lshl_add_u32 v26, v28, 2, v26
    v_lshlrev_b32 v28, 1, v28
    v_lshlrev_b32 v26, 7, v26
    v_and_b32 v24, 3, v0
    v_lshl_add_u32 v26, v24, 3, v26
    v_mul_u32_u24 v24, 6144, v3
    v_add_u32 v26, v26, v24
    v_add_u32 v26, 20480, v26
    s_mul_i32 s35, s52, 3
    s_add_u32 s47, s35, 0
    s_and_b32 s34, s47, 3
    s_lshr_b32 s47, s47, 2
    s_lshl_b32 s47, s47, 10
    v_xor_b32 v24, s34, v28
    v_xor_b32 v25, 1, v24
    v_lshl_add_u32 v24, v24, 5, v26
    v_lshl_add_u32 v25, v25, 5, v26
    v_add_u32 v240, s47, v24
    v_add_u32 v241, s47, v25
    s_add_u32 s47, s35, 1
    s_and_b32 s34, s47, 3
    s_lshr_b32 s47, s47, 2
    s_lshl_b32 s47, s47, 10
    v_xor_b32 v24, s34, v28
    v_xor_b32 v25, 1, v24
    v_lshl_add_u32 v24, v24, 5, v26
    v_lshl_add_u32 v25, v25, 5, v26
    v_add_u32 v242, s47, v24
    v_add_u32 v243, s47, v25
    s_add_u32 s47, s35, 2
    s_and_b32 s34, s47, 3
    s_lshr_b32 s47, s47, 2
    s_lshl_b32 s47, s47, 10
    v_xor_b32 v24, s34, v28
    v_xor_b32 v25, 1, v24
    v_lshl_add_u32 v24, v24, 5, v26
    v_lshl_add_u32 v25, v25, 5, v26
    v_add_u32 v244, s47, v24
    v_add_u32 v245, s47, v25
    s_mul_i32 s34, s35, 1280
    s_add_u32 s34, s34, s65
    s_lshl_b32 s35, s56, 7
    s_add_u32 s34, s34, s35
    s_add_u32 s34, s34, 868288
    v_and_b32 v25, 8, v0
    v_lshl_add_u32 v246, v0, 2, s34
    s_lshl3_add_u32 s34, s56, s65
    s_add_u32 s34, s34, 884992
    v_lshrrev_b32 v25, 1, v25
    v_add_u32 v247, s34, v25
    s_mov_b32 s58, 0xffff0000
    s_mov_b32 s59, 0x0000ffff
    s_mov_b32 s60, 0x0f0f0f0f
    s_mov_b32 s61, 0x0f0f0f0f
    v_mov_b32 v96, 0x3f803f80
    v_mov_b32 v97, 0x3f803f80
    v_mov_b32 v98, 0x3f803f80
    v_mov_b32 v99, 0x3f803f80
    v_mov_b32 v100, 0x3f803f80
    v_mov_b32 v101, 0x3f803f80
    v_mov_b32 v102, 0x3f803f80
    v_mov_b32 v103, 0x3f803f80
    s_lshl2_add_u32 s34, s53, s52
    s_mul_i32 s34, s34, 80
    s_add_u32 s34, s34, 32
    v_min_u32 v24, 47, v0
    v_add_u32 v24, s34, v24
    v_min_u32 v24, 3839, v24
    v_cvt_f32_u32 v25, v24
    v_add_f32 v25, 0.5, v25
    v_mul_f32 v25, 0x3b088889, v25
    v_cvt_u32_f32 v25, v25
    v_mul_u32_u24 v25, 480, v25
    s_mul_i32 s34, s27, 7680
    s_add_u32 s34, s34, 480
    v_add3_u32 v24, v24, v25, s34
    v_lshlrev_b32 v237, 7, v24
    s_lshl2_add_u32 s34, s53, s52
    s_mul_i32 s34, s34, 80
    s_add_u32 s34, s34, 0
    v_min_u32 v24, 31, v0
    v_add_u32 v24, s34, v24
    v_min_u32 v24, 3839, v24
    v_cvt_f32_u32 v25, v24
    v_add_f32 v25, 0.5, v25
    v_mul_f32 v25, 0x3b088889, v25
    v_cvt_u32_f32 v25, v25
    v_mul_u32_u24 v25, 480, v25
    s_mul_i32 s34, s27, 7680
    s_add_u32 s34, s34, 480
    v_add3_u32 v24, v24, v25, s34
    v_lshlrev_b32 v232, 7, v24
    s_waitcnt vmcnt(1)
    global_load_dwordx4 v[212:215], v8, s[8:9] offset:0 nt
    global_load_dwordx4 v[216:219], v8, s[8:9] offset:256 nt
    global_load_dwordx4 v[220:223], v8, s[8:9] offset:512 nt
    global_load_dword v231, v232, s[12:13]
    v_mfma_f32_16x16x32_bf16 v[64:67], v[200:203], v[56:59], v[64:67]
    v_mfma_f32_16x16x32_bf16 v[68:71], v[204:207], v[56:59], v[68:71]
    v_mfma_f32_16x16x32_bf16 v[72:75], v[208:211], v[56:59], v[72:75]
    s_waitcnt vmcnt(3)
    v_mfma_f32_16x16x32_bf16 v[64:67], v[212:215], v[60:63], v[64:67]
    s_waitcnt vmcnt(2)
    v_mfma_f32_16x16x32_bf16 v[68:71], v[216:219], v[60:63], v[68:71]
    s_waitcnt vmcnt(1)
    v_mfma_f32_16x16x32_bf16 v[72:75], v[220:223], v[60:63], v[72:75]
    global_load_dword v238, v237, s[12:13]
    s_mov_b64 exec, s[40:41]
    s_nop 1
    ds_write_b128 v27, v[64:67] offset:8192
    s_mov_b64 exec, s[42:43]
    ds_write_b128 v27, v[68:71] offset:8704
    s_mov_b64 exec, s[44:45]
    ds_write_b128 v27, v[72:75] offset:9216
    s_mov_b64 exec, -1
    s_cmp_lt_u32 s53, 10
    s_waitcnt lgkmcnt(0)
    s_barrier
    s_barrier
    s_cbranch_scc0 L_fin
    s_mov_b32 m0, s49
    s_add_u32 s49, s49, 1024
    global_load_lds_dwordx4 v30, s[32:33] nt
    s_add_u32 s32, s32, 128
    s_addc_u32 s33, s33, 0
    s_mov_b32 m0, s49
    s_add_u32 s49, s49, 1024
    global_load_lds_dwordx4 v30, s[32:33] nt
    s_add_u32 s32, s32, 128
    s_addc_u32 s33, s33, 0
    s_mov_b32 m0, s49
    s_add_u32 s49, s49, 1024
    global_load_lds_dwordx4 v30, s[32:33] nt
    s_add_u32 s32, s32, 24320
    s_addc_u32 s33, s33, 0
    s_mov_b32 m0, s49
    s_add_u32 s49, s49, 1024
    global_load_lds_dwordx4 v30, s[32:33] nt
    s_add_u32 s32, s32, 128
    s_addc_u32 s33, s33, 0
    s_mov_b32 m0, s49
    s_add_u32 s49, s49, 1024
    global_load_lds_dwordx4 v30, s[32:33] nt
    s_add_u32 s32, s32, 128
    s_addc_u32 s33, s33, 0
    s_mov_b32 m0, s49
    s_add_u32 s49, s49, 1024
    global_load_lds_dwordx4 v30, s[32:33] nt
    s_add_u32 s32, s32, 24320
    s_addc_u32 s33, s33, 0
    v_and_b32 v117, 0xffff0000, v116
    v_lshlrev_b32 v116, 16, v116
    s_mov_b32 s46, 0
    s_waitcnt vmcnt(0)
    s_barrier
    ds_read_b64_tr_b16 v[128:129], v240 offset:0
    ds_read_b64_tr_b16 v[130:131], v240 offset:3072
    ds_read_b64_tr_b16 v[132:133], v241 offset:256
    ds_read_b64_tr_b16 v[134:135], v241 offset:3328
    ds_read_b64_tr_b16 v[136:137], v242 offset:0
    ds_read_b64_tr_b16 v[138:139], v242 offset:3072
    ds_read_b64_tr_b16 v[140:141], v243 offset:256
    ds_read_b64_tr_b16 v[142:143], v243 offset:3328
    ds_read_b64_tr_b16 v[144:145], v244 offset:0
    ds_read_b64_tr_b16 v[146:147], v244 offset:3072
    ds_read_b64_tr_b16 v[148:149], v245 offset:256
    ds_read_b64_tr_b16 v[150:151], v245 offset:3328
    s_cmp_lg_u32 s26, 0
    s_cbranch_scc1 L_hwait
L_ypoll:
    global_load_dwordx4 v[64:67], v233, s[24:25] sc1
    global_load_dwordx4 v[68:71], v234, s[24:25] sc1
    global_load_dwordx4 v[72:75], v235, s[24:25] sc1
    global_load_dwordx4 v[76:79], v236, s[24:25] sc1
L_ychk:
    s_add_u32 s46, s46, 1
    s_waitcnt vmcnt(2)
    v_pk_add_f32 v[48:49], v[64:65], v[68:69]
    v_pk_add_f32 v[50:51], v[66:67], v[70:71]
    s_waitcnt vmcnt(0)
    v_pk_add_f32 v[52:53], v[72:73], v[76:77]
    v_pk_add_f32 v[54:55], v[74:75], v[78:79]
    v_pk_add_f32 v[48:49], v[48:49], v[52:53]
    v_pk_add_f32 v[50:51], v[50:51], v[54:55]
    v_pk_add_f32 v[52:53], v[48:49], v[50:51]
    v_cmp_u_f32 vcc, v52, v53
    s_cbranch_vccz L_ygot
    v_max3_u32 v52, v64, v65, v66
    v_max3_u32 v52, v52, v67, v68
    v_max3_u32 v52, v52, v69, v70
    v_max3_u32 v52, v52, v71, v72
    v_max3_u32 v52, v52, v73, v74
    v_max3_u32 v52, v52, v75, v76
    v_max3_u32 v52, v52, v77, v78
    v_max_u32 v52, v52, v79
    v_cmp_eq_u32 vcc, -1, v52
    s_cbranch_vccz L_ygot
    s_cmp_lt_u32 s46, 131072
    s_cbranch_scc1 L_ypoll
L_ygot:
    v_add_f32_dpp v54, v48, v48 row_ror:8 row_mask:0xf bank_mask:0x3
    v_add_f32_dpp v55, v49, v49 row_ror:8 row_mask:0xf bank_mask:0x3
    s_cmp_eq_u32 s37, 2
    v_add_f32_dpp v54, v50, v50 row_ror:8 row_mask:0xf bank_mask:0xc
    v_add_f32_dpp v55, v51, v51 row_ror:8 row_mask:0xf bank_mask:0xc
    s_nop 0
    v_add_f32_dpp v54, v54, v54 row_shl:4 row_mask:0xf bank_mask:0x5
    v_add_f32_dpp v55, v55, v55 row_shl:4 row_mask:0xf bank_mask:0x5
    v_cvt_pk_bf16_f32 v52, v54, v55
    v_lshlrev_b32 v48, 16, v52
    v_and_b32 v49, 0xffff0000, v52
    v_pk_add_f32 v[48:49], v[48:49], v[116:117]
    v_cvt_pk_bf16_f32 v52, v48, v49
    s_mov_b64 exec, s[60:61]
    ds_write_b32 v23, v52 offset:640
    s_mov_b64 exec, -1
    v_mov_b32_dpp v96, v52 row_newbcast:0 row_mask:0xf bank_mask:0x3
    v_mov_b32_dpp v97, v52 row_newbcast:1 row_mask:0xf bank_mask:0x3
    v_mov_b32_dpp v98, v52 row_newbcast:2 row_mask:0xf bank_mask:0x3
    v_mov_b32_dpp v99, v52 row_newbcast:3 row_mask:0xf bank_mask:0x3
    v_mov_b32_dpp v100, v52 row_newbcast:8 row_mask:0xf bank_mask:0x3
    v_mov_b32_dpp v101, v52 row_newbcast:9 row_mask:0xf bank_mask:0x3
    v_mov_b32_dpp v102, v52 row_newbcast:10 row_mask:0xf bank_mask:0x3
    v_mov_b32_dpp v103, v52 row_newbcast:11 row_mask:0xf bank_mask:0x3
    s_waitcnt lgkmcnt(0)
    s_barrier
    v_mfma_f32_16x16x32_bf16 v[120:123], v[96:99], v[96:99], 0
    v_mfma_f32_16x16x32_bf16 v[104:107], v[96:99], v[128:131], 0
    v_mfma_f32_16x16x32_bf16 v[108:111], v[96:99], v[136:139], 0
    v_mfma_f32_16x16x32_bf16 v[112:115], v[96:99], v[144:147], 0
    v_mfma_f32_16x16x32_bf16 v[120:123], v[100:103], v[100:103], v[120:123]
    v_mfma_f32_16x16x32_bf16 v[104:107], v[100:103], v[132:135], v[104:107]
    v_mfma_f32_16x16x32_bf16 v[108:111], v[100:103], v[140:143], v[108:111]
    v_mfma_f32_16x16x32_bf16 v[112:115], v[100:103], v[148:151], v[112:115]
    s_mov_b64 exec, s[60:61]
    s_cbranch_scc0 L_g0_slow
    global_store_dword v239, v52, s[24:25]
    s_mov_b64 exec, 0x101
    s_nop 0
    global_store_dword v247, v120, s[24:25]
    s_mov_b64 exec, s[58:59]
    global_store_dword v246, v104, s[24:25]
    global_store_dword v246, v108, s[24:25] offset:1280
    global_store_dword v246, v112, s[24:25] offset:2560
    s_branch L_fin
L_g0_slow:
    global_store_dword v239, v52, s[24:25] sc1
    s_mov_b64 exec, 0x101
    s_nop 0
    global_store_dword v247, v120, s[24:25] sc1
    s_mov_b64 exec, s[58:59]
    global_store_dword v246, v104, s[24:25] sc1
    global_store_dword v246, v108, s[24:25] offset:1280 sc1
    global_store_dword v246, v112, s[24:25] offset:2560 sc1
    s_branch L_fin
L_hwait:
    s_mov_b64 exec, s[40:41]
    s_cmp_eq_u32 s37, 2
    s_waitcnt lgkmcnt(0)
    s_barrier
    ds_read_b128 v[96:99], v22 offset:640
    ds_read_b128 v[100:103], v22 offset:704
    s_mov_b64 exec, -1
    s_waitcnt lgkmcnt(1)
    v_mfma_f32_16x16x32_bf16 v[104:107], v[96:99], v[128:131], 0
    v_mfma_f32_16x16x32_bf16 v[108:111], v[96:99], v[136:139], 0
    v_mfma_f32_16x16x32_bf16 v[112:115], v[96:99], v[144:147], 0
    s_waitcnt lgkmcnt(0)
    v_mfma_f32_16x16x32_bf16 v[104:107], v[100:103], v[132:135], v[104:107]
    v_mfma_f32_16x16x32_bf16 v[108:111], v[100:103], v[140:143], v[108:111]
    v_mfma_f32_16x16x32_bf16 v[112:115], v[100:103], v[148:151], v[112:115]
    s_mov_b64 exec, s[58:59]
    s_nop 3
    s_cbranch_scc0 L_g1_slow
    global_store_dword v246, v104, s[24:25]
    global_store_dword v246, v108, s[24:25] offset:1280
    global_store_dword v246, v112, s[24:25] offset:2560
    s_branch L_fin
L_g1_slow:
    global_store_dword v246, v104, s[24:25] sc1
    global_store_dword v246, v108, s[24:25] offset:1280 sc1
    global_store_dword v246, v112, s[24:25] offset:2560 sc1
    s_branch L_fin
L_s_setup:
    s_cmp_lt_u32 s28, 12
    s_cbranch_scc0 L_red_setup
    v_lshrrev_b32 v31, 3, v0
    v_and_b32 v24, 6, v31
    v_and_b32 v25, 7, v0
    v_xor_b32 v24, v24, v25
    v_mul_u32_u24 v31, 1280, v31
    v_lshl_add_u32 v31, v24, 4, v31
    s_mul_i32 s34, s31, 20480
    s_mul_i32 s35, s52, 10
    s_lshr_b32 s47, s35, 2
    s_mul_i32 s49, s52, 5120
    s_add_u32 s49, s49, 20480
    s_lshl_b32 s47, s47, 7
    s_add_u32 s34, s34, s47
    s_and_b32 s47, s52, 1
    s_mul_i32 s47, s47, 10240
    s_add_u32 s34, s34, s47
    s_add_u32 s32, s18, s34
    s_addc_u32 s33, s19, 0
    s_mov_b32 s56, 10240
    s_mov_b32 s57, -10112
    s_cmp_eq_u32 s47, 0
    s_cselect_b32 s54, s56, s57
    s_cselect_b32 s55, 0, -1
    s_cselect_b32 s56, s57, s56
    s_cselect_b32 s57, -1, 0
    v_and_b32 v28, 1, v3
    v_lshrrev_b32 v29, 2, v2
    v_lshl_add_u32 v29, v28, 2, v29
    v_bfe_u32 v28, v29, 1, 2
    v_lshlrev_b32 v29, 7, v29
    v_and_b32 v24, 3, v0
    v_lshl_add_u32 v29, v24, 3, v29
    v_lshrrev_b32 v24, 1, v3
    v_lshl_add_u32 v29, v24, 10, v29
    v_add_u32 v29, 20480, v29
    s_add_u32 s47, s35, 0
    s_and_b32 s34, s47, 3
    s_lshr_b32 s47, s47, 2
    s_lshl_b32 s47, s47, 11
    v_xor_b32 v24, s34, v28
    v_lshl_add_u32 v24, v24, 5, v29
    v_add_u32 v233, s47, v24
    s_add_u32 s47, s35, 1
    s_and_b32 s34, s47, 3
    s_lshr_b32 s47, s47, 2
    s_lshl_b32 s47, s47, 11
    v_xor_b32 v24, s34, v28
    v_lshl_add_u32 v24, v24, 5, v29
    v_add_u32 v234, s47, v24
    s_add_u32 s47, s35, 2
    s_and_b32 s34, s47, 3
    s_lshr_b32 s47, s47, 2
    s_lshl_b32 s47, s47, 11
    v_xor_b32 v24, s34, v28
    v_lshl_add_u32 v24, v24, 5, v29
    v_add_u32 v235, s47, v24
    s_add_u32 s47, s35, 3
    s_and_b32 s34, s47, 3
    s_lshr_b32 s47, s47, 2
    s_lshl_b32 s47, s47, 11
    v_xor_b32 v24, s34, v28
    v_lshl_add_u32 v24, v24, 5, v29
    v_add_u32 v236, s47, v24
    s_add_u32 s47, s35, 4
    s_and_b32 s34, s47, 3
    s_lshr_b32 s47, s47, 2
    s_lshl_b32 s47, s47, 11
    v_xor_b32 v24, s34, v28
    v_lshl_add_u32 v24, v24, 5, v29
    v_add_u32 v237, s47, v24
    s_add_u32 s47, s35, 5
    s_and_b32 s34, s47, 3
    s_lshr_b32 s47, s47, 2
    s_lshl_b32 s47, s47, 11
    v_xor_b32 v24, s34, v28
    v_lshl_add_u32 v24, v24, 5, v29
    v_add_u32 v238, s47, v24
    s_add_u32 s47, s35, 6
    s_and_b32 s34, s47, 3
    s_lshr_b32 s47, s47, 2
    s_lshl_b32 s47, s47, 11
    v_xor_b32 v24, s34, v28
    v_lshl_add_u32 v24, v24, 5, v29
    v_add_u32 v239, s47, v24
    s_add_u32 s47, s35, 7
    s_and_b32 s34, s47, 3
    s_lshr_b32 s47, s47, 2
    s_lshl_b32 s47, s47, 11
    v_xor_b32 v24, s34, v28
    v_lshl_add_u32 v24, v24, 5, v29
    v_add_u32 v240, s47, v24
    s_add_u32 s47, s35, 8
    s_and_b32 s34, s47, 3
    s_lshr_b32 s47, s47, 2
    s_lshl_b32 s47, s47, 11
    v_xor_b32 v24, s34, v28
    v_lshl_add_u32 v24, v24, 5, v29
    v_add_u32 v241, s47, v24
    s_add_u32 s47, s35, 9
    s_and_b32 s34, s47, 3
    s_lshr_b32 s47, s47, 2
    s_lshl_b32 s47, s47, 11
    v_xor_b32 v24, s34, v28
    v_lshl_add_u32 v24, v24, 5, v29
    v_add_u32 v242, s47, v24
    v_lshrrev_b32 v26, 3, v2
    v_and_b32 v24, 1, v0
    v_lshlrev_b32 v24, 3, v24
    v_and_b32 v25, 2, v0
    v_lshl_add_u32 v24, v25, 5, v24
    v_lshl_add_u32 v24, v3, 4, v24
    v_lshl_add_u32 v24, v26, 7, v24
    s_mul_i32 s35, s28, 1280
    s_add_u32 s35, s35, s65
    s_add_u32 s35, s35, 868352
    v_add_u32 v24, s35, v24
    s_add_u32 s35, s65, 884992
    v_lshl_add_u32 v25, v26, 3, s35
    s_mov_b32 s60, 0x0f0f0f0f
    s_mov_b32 s61, 0x0f0f0f0f
    v_mov_b32 v26, 256
    v_cndmask_b32 v118, v25, v24, s[60:61]
    v_cndmask_b32 v26, 16, v26, s[60:61]
    v_add_u32 v119, v26, v118
    v_add_u32 v120, v26, v119
    v_add_u32 v121, v26, v120
    v_add_u32 v122, v26, v121
    s_mul_i32 s34, s31, 2560
    s_mul_i32 s35, s52, 640
    s_add_u32 s34, s34, s35
    s_add_u32 s34, s34, 565248
    v_lshl_add_u32 v244, v0, 2, s34
    v_mov_b32 v245, 0x3acccccd
    v_lshrrev_b32 v24, 2, v0
    v_mul_u32_u24 v24, 2560, v24
    v_and_b32 v25, 3, v0
    v_lshl_add_u32 v24, v25, 3, v24
    s_lshl_b32 s34, s31, 5
    s_add_u32 s34, s34, 565248
    v_add_u32 v246, s34, v24
    s_lshl_b32 s34, s31, 4
    v_lshl_add_u32 v252, v25, 2, s34
    s_add_u32 s34, s65, 883712
    v_min_u32 v254, 1276, v252
    v_add_u32 v254, s34, v254
    v_add_u32 v247, 40960, v246
    v_add_u32 v248, 81920, v246
    v_add_u32 v249, 122880, v246
    v_add_u32 v250, 163840, v246
    v_add_u32 v251, 204800, v246
    v_mov_b32 v96, 0
    v_mov_b32 v97, 0
    v_mov_b32 v98, 0
    v_mov_b32 v99, 0
    v_mov_b32 v100, 0
    v_mov_b32 v101, 0
    v_mov_b32 v102, 0
    v_mov_b32 v103, 0
L_red_setup:
    s_waitcnt vmcnt(0)
    global_load_dwordx4 v[212:215], v8, s[8:9] offset:0 nt
    global_load_dwordx4 v[216:219], v8, s[8:9] offset:256 nt
    global_load_dwordx4 v[220:223], v8, s[8:9] offset:512 nt
    v_mfma_f32_16x16x32_bf16 v[64:67], v[200:203], v[56:59], v[64:67]
    v_mfma_f32_16x16x32_bf16 v[68:71], v[204:207], v[56:59], v[68:71]
    v_mfma_f32_16x16x32_bf16 v[72:75], v[208:211], v[56:59], v[72:75]
    s_mov_b32 s46, 0
L_mspin:
    ds_read_b32 v25, v11 offset:4
    s_add_u32 s46, s46, 1
    s_waitcnt lgkmcnt(0)
    v_readfirstlane_b32 s35, v25
    s_cmp_eq_u32 s35, 8
    s_cbranch_scc1 L_mspin_x
    s_sleep 1
    s_cmp_lt_u32 s46, 1048576
    s_cbranch_scc1 L_mspin
L_mspin_x:
    v_and_b32 v5, 7, v0
    v_lshlrev_b32 v6, 3, v5
    ds_read_b64 v[28:29], v6 offset:64
    s_lshl_b32 s35, s52, 8
    v_lshrrev_b32 v4, 5, v0
    v_lshlrev_b32 v4, 7, v4
    v_lshl_add_u32 v4, v5, 4, v4
    v_bfe_u32 v6, v0, 3, 2
    v_lshl_add_u32 v4, v6, 2, v4
    v_add_u32 v4, s35, v4
    v_add_u32 v4, 8192, v4
    s_and_b32 s35, s29, 3
    s_lshl_b32 s35, s35, 12
    s_add_u32 s35, s35, s65
    s_add_u32 s35, s35, 851968
    s_lshl_b32 s47, s30, 3
    s_add_u32 s47, s47, s35
    v_mov_b32 v7, s47
    s_lshl_b32 s47, s30, 4
    s_add_u32 s35, s35, s47
    s_lshl_b32 s47, s52, 10
    s_add_u32 s35, s35, s47
    v_lshlrev_b32 v6, 8, v3
    v_and_b32 v5, 4, v0
    v_lshl_add_u32 v6, v5, 5, v6
    v_and_b32 v5, 8, v0
    v_add_u32 v6, v5, v6
    v_and_b32 v5, 3, v0
    v_lshl_add_u32 v6, v5, 1, v6
    v_add_u32 v6, s35, v6
    s_mov_b32 s58, 0x55555555
    s_mov_b32 s59, 0x55555555
    s_waitcnt lgkmcnt(0)
    v_max_f32_dpp v16, v28, v28 row_ror:1 row_mask:0xf bank_mask:0xf
    s_nop 1
    v_max_f32_dpp v16, v16, v16 row_ror:2 row_mask:0xf bank_mask:0xf
    s_nop 1
    v_max_f32_dpp v16, v16, v16 row_ror:4 row_mask:0xf bank_mask:0xf
    v_sub_f32 v18, v28, v16
    v_mul_f32 v18, 0x3fb8aa3b, v18
    v_exp_f32 v18, v18
    s_nop 0
    v_mul_f32 v17, v18, v29
    s_nop 1
    v_add_f32_dpp v17, v17, v17 row_ror:1 row_mask:0xf bank_mask:0xf
    s_nop 1
    v_add_f32_dpp v17, v17, v17 row_ror:2 row_mask:0xf bank_mask:0xf
    s_nop 1
    v_add_f32_dpp v17, v17, v17 row_ror:4 row_mask:0xf bank_mask:0xf
    s_cmp_lg_u32 s26, 7
    s_cbranch_scc1 L_noml
    s_mov_b64 exec, 1
    s_cmp_eq_u32 s37, 2
    s_cbranch_scc0 L_ml_slow
    global_store_dwordx2 v7, v[16:17], s[24:25] offset:3072
L_ml_done:
    s_mov_b64 exec, -1
    s_waitcnt vmcnt(3)
    v_mfma_f32_16x16x32_bf16 v[64:67], v[212:215], v[60:63], v[64:67]
    s_waitcnt vmcnt(2)
    v_mfma_f32_16x16x32_bf16 v[68:71], v[216:219], v[60:63], v[68:71]
    s_waitcnt vmcnt(1)
    v_mfma_f32_16x16x32_bf16 v[72:75], v[220:223], v[60:63], v[72:75]
    s_mov_b64 exec, s[40:41]
    s_nop 2
    ds_write_b128 v27, v[64:67] offset:8192
    s_mov_b64 exec, s[42:43]
    ds_write_b128 v27, v[68:71] offset:8704
    s_mov_b64 exec, s[44:45]
    ds_write_b128 v27, v[72:75] offset:9216
    s_mov_b64 exec, -1
    s_waitcnt lgkmcnt(0)
    s_barrier
    s_branch L_pub_done
L_noml:
    s_waitcnt vmcnt(2)
    v_mfma_f32_16x16x32_bf16 v[64:67], v[212:215], v[60:63], v[64:67]
    s_waitcnt vmcnt(1)
    v_mfma_f32_16x16x32_bf16 v[68:71], v[216:219], v[60:63], v[68:71]
    s_waitcnt vmcnt(0)
    v_mfma_f32_16x16x32_bf16 v[72:75], v[220:223], v[60:63], v[72:75]
    s_mov_b64 exec, s[40:41]
    s_nop 2
    ds_write_b128 v27, v[64:67] offset:8192
    s_mov_b64 exec, s[42:43]
    ds_write_b128 v27, v[68:71] offset:8704
    s_mov_b64 exec, s[44:45]
    ds_write_b128 v27, v[72:75] offset:9216
    s_mov_b64 exec, -1
    s_waitcnt lgkmcnt(0)
    s_barrier
    ds_read2st64_b32 v[80:81], v4 offset0:0 offset1:3
    ds_read2st64_b32 v[82:83], v4 offset0:6 offset1:9
    ds_read2st64_b32 v[84:85], v4 offset0:12 offset1:15
    ds_read2st64_b32 v[86:87], v4 offset0:18 offset1:21
    ds_read2st64_b32 v[88:89], v4 offset0:24 offset1:27
    ds_read2st64_b32 v[90:91], v4 offset0:30 offset1:33
    ds_read2st64_b32 v[92:93], v4 offset0:36 offset1:39
    ds_read2st64_b32 v[94:95], v4 offset0:42 offset1:45
    s_cmp_eq_u32 s37, 2
    s_waitcnt lgkmcnt(6)
    v_mul_f32_dpp v19, v18, v80 row_newbcast:0 row_mask:0xf bank_mask:0xf
    v_mul_f32_dpp v20, v18, v81 row_newbcast:0 row_mask:0xf bank_mask:0xf
    v_mul_f32_dpp v21, v18, v82 row_newbcast:1 row_mask:0xf bank_mask:0xf
    v_mul_f32_dpp v22, v18, v83 row_newbcast:1 row_mask:0xf bank_mask:0xf
    s_waitcnt lgkmcnt(4)
    v_fmac_f32_dpp v19, v18, v84 row_newbcast:2 row_mask:0xf bank_mask:0xf
    v_fmac_f32_dpp v20, v18, v85 row_newbcast:2 row_mask:0xf bank_mask:0xf
    v_fmac_f32_dpp v21, v18, v86 row_newbcast:3 row_mask:0xf bank_mask:0xf
    v_fmac_f32_dpp v22, v18, v87 row_newbcast:3 row_mask:0xf bank_mask:0xf
    s_waitcnt lgkmcnt(2)
    v_fmac_f32_dpp v19, v18, v88 row_newbcast:4 row_mask:0xf bank_mask:0xf
    v_fmac_f32_dpp v20, v18, v89 row_newbcast:4 row_mask:0xf bank_mask:0xf
    v_fmac_f32_dpp v21, v18, v90 row_newbcast:5 row_mask:0xf bank_mask:0xf
    v_fmac_f32_dpp v22, v18, v91 row_newbcast:5 row_mask:0xf bank_mask:0xf
    s_waitcnt lgkmcnt(0)
    v_fmac_f32_dpp v19, v18, v92 row_newbcast:6 row_mask:0xf bank_mask:0xf
    v_fmac_f32_dpp v20, v18, v93 row_newbcast:6 row_mask:0xf bank_mask:0xf
    v_fmac_f32_dpp v21, v18, v94 row_newbcast:7 row_mask:0xf bank_mask:0xf
    v_fmac_f32_dpp v22, v18, v95 row_newbcast:7 row_mask:0xf bank_mask:0xf
    v_add_f32 v19, v19, v20
    v_add_f32 v21, v21, v22
    v_add_f32 v19, v19, v21
    s_nop 1
    v_mov_b32_dpp v20, v19 quad_perm:[1,1,3,3] row_mask:0xf bank_mask:0xf
    v_cvt_pk_bf16_f32 v19, v19, v20
    s_mov_b64 exec, s[58:59]
    s_cbranch_scc0 L_pub_slow
    global_store_dword v6, v19, s[24:25]
L_pub_done:
    s_mov_b64 exec, -1
    s_cmp_lt_u32 s28, 12
    s_barrier
    s_cbranch_scc0 L_fin
    s_barrier
    s_barrier
    s_mov_b32 m0, s49
    s_add_u32 s49, s49, 1024
    global_load_lds_dwordx4 v31, s[32:33] nt
    s_add_u32 s32, s32, s54
    s_addc_u32 s33, s33, s55
    s_mov_b32 m0, s49
    s_add_u32 s49, s49, 1024
    global_load_lds_dwordx4 v31, s[32:33] nt
    s_add_u32 s32, s32, s56
    s_addc_u32 s33, s33, s57
    s_mov_b32 m0, s49
    s_add_u32 s49, s49, 1024
    global_load_lds_dwordx4 v31, s[32:33] nt
    s_add_u32 s32, s32, s54
    s_addc_u32 s33, s33, s55
    s_mov_b32 m0, s49
    s_add_u32 s49, s49, 1024
    global_load_lds_dwordx4 v31, s[32:33] nt
    s_add_u32 s32, s32, s56
    s_addc_u32 s33, s33, s57
    s_mov_b32 m0, s49
    s_add_u32 s49, s49, 1024
    global_load_lds_dwordx4 v31, s[32:33] nt
    s_add_u32 s32, s32, s54
    s_addc_u32 s33, s33, s55
    s_cmp_lg_u32 s26, 4
    s_cbranch_scc1 L_notouch
    global_load_dwordx2 v[170:171], v118, s[24:25] sc1
    global_load_dwordx2 v[172:173], v119, s[24:25] sc1
    global_load_dwordx2 v[174:175], v120, s[24:25] sc1
    global_load_dwordx2 v[176:177], v121, s[24:25] sc1
    global_load_dwordx2 v[178:179], v122, s[24:25] sc1
    global_load_dword v26, v254, s[24:25] sc1
L_notouch:
    s_waitcnt vmcnt(0)
    s_barrier
    ds_read_b64_tr_b16 v[148:149], v233
    ds_read_b64_tr_b16 v[150:151], v234
    ds_read_b64_tr_b16 v[152:153], v235
    ds_read_b64_tr_b16 v[154:155], v236
    ds_read_b64_tr_b16 v[156:157], v237
    ds_read_b64_tr_b16 v[158:159], v238
    ds_read_b64_tr_b16 v[160:161], v239
    ds_read_b64_tr_b16 v[162:163], v240
    ds_read_b64_tr_b16 v[164:165], v241
    ds_read_b64_tr_b16 v[166:167], v242
    s_mov_b32 s46, 0
    s_mov_b32 s62, 0x1f1f1f1f
    s_mov_b32 s63, 0x1f1f1f1f
    s_mov_b64 exec, s[62:63]
L_gpoll:
    global_load_dwordx2 v[170:171], v118, s[24:25] sc1
    global_load_dwordx2 v[172:173], v119, s[24:25] sc1
    global_load_dwordx2 v[174:175], v120, s[24:25] sc1
    global_load_dwordx2 v[176:177], v121, s[24:25] sc1
    global_load_dwordx2 v[178:179], v122, s[24:25] sc1
    s_add_u32 s46, s46, 1
    s_waitcnt vmcnt(1)
    v_pk_add_f32 v[32:33], v[170:171], v[172:173]
    v_pk_add_f32 v[34:35], v[174:175], v[176:177]
    v_pk_add_f32 v[32:33], v[32:33], v[34:35]
    s_waitcnt vmcnt(0)
    v_pk_add_f32 v[32:33], v[32:33], v[178:179]
    v_cmp_u_f32 vcc, v32, v33
    s_cbranch_vccz L_ggot
    v_max3_u32 v34, v170, v171, v172
    v_max3_u32 v34, v34, v173, v174
    v_max3_u32 v34, v34, v175, v176
    v_max3_u32 v34, v34, v177, v178
    v_max_u32 v34, v34, v179
    v_cmp_eq_u32 vcc, -1, v34
    s_cbranch_vccz L_ggot
    s_cmp_lt_u32 s46, 131072
    s_cbranch_scc1 L_gpoll
L_ggot:
    s_mov_b64 exec, -1
    v_add_f32_dpp v33, v33, v33 row_ror:8 row_mask:0xf bank_mask:0xf
    v_add_f32_dpp v32, v32, v32 row_ror:8 row_mask:0xf bank_mask:0xf
    s_mov_b32 s46, 0
    v_mul_f32_dpp v37, v33, v245 row_newbcast:4 row_mask:0xf bank_mask:0xf
    v_mul_f32_dpp v34, v32, v245 row_newbcast:4 row_mask:0xf bank_mask:0xf
    v_cvt_pk_bf16_f32 v35, v37, v37
    v_fma_f32 v34, -v37, v37, v34
    v_lshlrev_b32 v35, 16, v35
    v_max_f32 v34, 0, v34
    v_cvt_pk_bf16_f32 v34, v34, v34
    v_mul_f32_dpp v38, v32, v35 row_shl:2 row_mask:0xf bank_mask:0xf
    v_mul_f32_dpp v39, v33, v35 row_shl:2 row_mask:0xf bank_mask:0xf
    v_lshlrev_b32 v34, 16, v34
    v_sub_f32 v32, v32, v38
    v_sub_f32 v33, v33, v39
    v_add_f32 v34, 0x3727c5ac, v34
    v_max_f32 v32, 0, v32
    v_max_f32 v33, 0, v33
    v_cvt_pk_bf16_f32 v34, v34, v34
    v_cvt_pk_bf16_f32 v36, v32, v33
    s_waitcnt lgkmcnt(0)
    v_lshlrev_b32 v34, 16, v34
    v_sqrt_f32 v34, v34
    v_mov_b32_dpp v96, v36 row_newbcast:0 row_mask:0xf bank_mask:0x1
    v_mov_b32_dpp v97, v36 row_newbcast:1 row_mask:0xf bank_mask:0x1
    v_mov_b32_dpp v98, v36 row_newbcast:0 row_mask:0xf bank_mask:0x2
    v_mov_b32_dpp v99, v36 row_newbcast:1 row_mask:0xf bank_mask:0x2
    v_mfma_f32_16x16x16_bf16 v[68:71], v[96:97], v[148:149], 0
    v_mov_b32_dpp v100, v36 row_newbcast:0 row_mask:0xf bank_mask:0x4
    v_mfma_f32_16x16x16_bf16 v[72:75], v[96:97], v[156:157], 0
    v_mov_b32_dpp v101, v36 row_newbcast:1 row_mask:0xf bank_mask:0x4
    v_mfma_f32_16x16x16_bf16 v[76:79], v[96:97], v[164:165], 0
    v_mov_b32_dpp v102, v36 row_newbcast:0 row_mask:0xf bank_mask:0x8
    v_mfma_f32_16x16x16_bf16 v[68:71], v[98:99], v[150:151], v[68:71]
    v_mov_b32_dpp v103, v36 row_newbcast:1 row_mask:0xf bank_mask:0x8
    v_mfma_f32_16x16x16_bf16 v[72:75], v[98:99], v[158:159], v[72:75]
    v_cvt_pk_bf16_f32 v34, v34, v34
    v_mfma_f32_16x16x16_bf16 v[76:79], v[98:99], v[166:167], v[76:79]
    v_lshlrev_b32 v34, 16, v34
    v_mfma_f32_16x16x16_bf16 v[68:71], v[100:101], v[152:153], v[68:71]
    v_rcp_f32 v34, v34
    v_mfma_f32_16x16x16_bf16 v[72:75], v[100:101], v[160:161], v[72:75]
    v_mfma_f32_16x16x16_bf16 v[68:71], v[102:103], v[154:155], v[68:71]
    s_nop 0
    v_mfma_f32_16x16x16_bf16 v[72:75], v[102:103], v[162:163], v[72:75]
    s_nop 0
    v_mul_f32 v76, v76, v34
    s_mov_b32 exec_hi, 0
    global_store_dword v244, v76, s[24:25] offset:512 sc1
    s_mov_b64 exec, -1
    s_nop 0
    v_mul_f32 v68, v68, v34
    global_store_dword v244, v68, s[24:25] sc1
    v_mul_f32 v72, v72, v34
    global_store_dword v244, v72, s[24:25] offset:256 sc1
    s_cmp_lg_u32 s26, 4
    s_cbranch_scc1 L_fin
    s_cmp_lt_u32 s31, 80
    s_cbranch_scc0 L_fin
    s_waitcnt vmcnt(0)
L_zpoll:
    global_load_dword v26, v254, s[24:25] sc1
    global_load_dwordx2 v[32:33], v246, s[24:25] sc1
    global_load_dwordx2 v[34:35], v247, s[24:25] sc1
    global_load_dwordx2 v[36:37], v248, s[24:25] sc1
    global_load_dwordx2 v[38:39], v249, s[24:25] sc1
    global_load_dwordx2 v[40:41], v250, s[24:25] sc1
    global_load_dwordx2 v[42:43], v251, s[24:25] sc1
    s_add_u32 s46, s46, 1
    s_waitcnt vmcnt(0)
    v_pk_add_f32 v[48:49], v[32:33], v[34:35]
    v_pk_add_f32 v[50:51], v[36:37], v[38:39]
    v_pk_add_f32 v[52:53], v[40:41], v[42:43]
    v_pk_add_f32 v[48:49], v[48:49], v[50:51]
    v_pk_add_f32 v[48:49], v[48:49], v[52:53]
    v_cmp_u_f32 vcc, v48, v49
    v_cmp_eq_u32 s[50:51], -1, v26
    s_or_b64 vcc, vcc, s[50:51]
    s_cbranch_vccz L_zgot
    v_max3_u32 v50, v32, v33, v34
    v_max3_u32 v50, v50, v35, v36
    v_max3_u32 v50, v50, v37, v38
    v_max3_u32 v50, v50, v39, v40
    v_max3_u32 v50, v50, v41, v42
    v_max3_u32 v50, v50, v43, v26
    v_cmp_eq_u32 vcc, -1, v50
    s_cbranch_vccz L_zgot
    s_cmp_lt_u32 s46, 131072
    s_cbranch_scc1 L_zpoll
L_zgot:
    v_add_f32_dpp v48, v48, v48 row_ror:4 row_mask:0xf bank_mask:0xf
    v_add_f32_dpp v49, v49, v49 row_ror:4 row_mask:0xf bank_mask:0xf
    s_nop 0
    v_add_f32_dpp v48, v48, v48 row_ror:8 row_mask:0xf bank_mask:0xf
    v_add_f32_dpp v49, v49, v49 row_ror:8 row_mask:0xf bank_mask:0xf
    v_mov_b32 v50, v48
    v_mov_b32 v51, v49
    v_lshlrev_b32 v52, 16, v26
    v_permlane16_swap_b32 v48, v50
    v_permlane16_swap_b32 v49, v51
    v_pk_add_f32 v[48:49], v[48:49], v[50:51]
    v_mov_b32 v50, v48
    v_mov_b32 v51, v49
    v_and_b32 v53, 0xffff0000, v26
    v_permlane32_swap_b32 v48, v50
    v_permlane32_swap_b32 v49, v51
    v_pk_add_f32 v[48:49], v[48:49], v[50:51]
    v_cvt_pk_bf16_f32 v50, v48, v49
    v_lshlrev_b32 v48, 16, v50
    v_and_b32 v49, 0xffff0000, v50
    v_pk_add_f32 v[48:49], v[48:49], v[52:53]
    v_cvt_pk_bf16_f32 v50, v48, v49
    s_mov_b64 exec, 15
    global_store_dword v252, v50, s[20:21]
L_fin:
L_end:
    s_endpgm
L_pub_slow:
    global_store_dword v6, v19, s[24:25] sc1
    s_branch L_pub_done
L_ml_slow:
    global_store_dwordx2 v7, v[16:17], s[24:25] offset:3072 sc1
    s_branch L_ml_done
L_control:
    global_load_dword v236, v7, s[4:5] offset:0
    global_load_dword v237, v7, s[4:5] offset:256
    global_load_dword v238, v7, s[4:5] offset:512
    global_load_dword v239, v7, s[4:5] offset:768
    global_load_dword v240, v7, s[4:5] offset:1024
    global_load_dword v241, v11, s[24:25] sc1
    v_mul_u32_u24 v24, 768, v3
    v_lshl_add_u32 v24, v2, 4, v24
    v_add_u32 v8, s34, v24
    s_mov_b32 s40, 0x00ff00ff
    s_mov_b32 s41, 0x00ff00ff
    s_mov_b32 s42, 0x00ff00ff
    s_mov_b32 s43, 0xff00ff00
    s_mov_b32 s44, 0xff00ff00
    s_mov_b32 s45, 0xff00ff00
    v_and_b32 v24, 1, v0
    v_lshlrev_b32 v24, 4, v24
    v_mov_b32 v25, 0xffff
    v_lshlrev_b32 v24, v24, v25
    v_bfe_u32 v25, v0, 1, 2
    v_cmp_eq_u32 vcc, 0, v25
    s_nop 1
    v_cndmask_b32 v12, 0, v24, vcc
    v_cmp_eq_u32 vcc, 1, v25
    s_nop 1
    v_cndmask_b32 v13, 0, v24, vcc
    v_cmp_eq_u32 vcc, 2, v25
    s_nop 1
    v_cndmask_b32 v14, 0, v24, vcc
    v_cmp_eq_u32 vcc, 3, v25
    s_nop 1
    v_cndmask_b32 v15, 0, v24, vcc
    s_waitcnt vmcnt(6)
    global_load_dwordx4 v[32:35], v4, s[6:7] offset:0 nt
    global_load_dwordx4 v[36:39], v4, s[6:7] offset:256 nt
    global_load_dwordx4 v[40:43], v4, s[6:7] offset:512 nt
    s_cmp_eq_u32 s66, 7
    s_cselect_b32 s67, -1376256, s68
    v_add_u32 v4, s67, v4
    s_waitcnt lgkmcnt(0)
    s_barrier
    s_setprio 3
    s_mov_b32 s35, 0xffff0000
    s_waitcnt vmcnt(3)
    v_lshlrev_b32 v242, 16, v236
    v_and_b32 v243, s35, v236
    v_lshlrev_b32 v244, 16, v237
    v_and_b32 v245, s35, v237
    v_lshlrev_b32 v246, 16, v238
    v_and_b32 v247, s35, v238
    v_lshlrev_b32 v248, 16, v239
    v_and_b32 v249, s35, v239
    v_lshlrev_b32 v250, 16, v240
    v_and_b32 v251, s35, v240
    v_readfirstlane_b32 s36, v241
    v_add_f32 v24, v242, v243
    v_add_f32 v25, v244, v245
    v_add_f32 v26, v246, v247
    v_add_f32 v27, v248, v249
    v_add_f32 v28, v250, v251
    v_add_f32 v24, v24, v25
    v_add_f32 v26, v26, v27
    v_add_f32 v24, v24, v28
    v_add_f32 v24, v24, v26
    s_mul_i32 s36, s36, 0x9e3779b1
    s_add_u32 s36, s36, 0x7f4a7c15
    v_add_f32_dpp v24, v24, v24 row_ror:1 row_mask:0xf bank_mask:0xf
    s_nop 1
    v_add_f32_dpp v24, v24, v24 row_ror:2 row_mask:0xf bank_mask:0xf
    s_nop 1
    v_add_f32_dpp v24, v24, v24 row_ror:4 row_mask:0xf bank_mask:0xf
    s_nop 1
    v_add_f32_dpp v24, v24, v24 row_ror:8 row_mask:0xf bank_mask:0xf
    s_nop 1
    v_add_f32_dpp v24, v24, v24 row_bcast:15 row_mask:0xa bank_mask:0xf
    s_nop 1
    v_add_f32_dpp v24, v24, v24 row_bcast:31 row_mask:0xc bank_mask:0xf
    s_nop 0
    v_readlane_b32 s34, v24, 63
    s_nop 1
    v_mov_b32 v25, s34
    v_mul_f32 v25, 0x3acccccd, v25
    v_sub_f32 v26, v242, v25
    v_mul_f32 v24, v26, v26
    v_sub_f32 v26, v243, v25
    v_fmac_f32 v24, v26, v26
    v_sub_f32 v26, v244, v25
    v_fmac_f32 v24, v26, v26
    v_sub_f32 v26, v245, v25
    v_fmac_f32 v24, v26, v26
    v_sub_f32 v26, v246, v25
    v_fmac_f32 v24, v26, v26
    v_sub_f32 v26, v247, v25
    v_fmac_f32 v24, v26, v26
    v_sub_f32 v26, v248, v25
    v_fmac_f32 v24, v26, v26
    v_sub_f32 v26, v249, v25
    v_fmac_f32 v24, v26, v26
    v_sub_f32 v26, v250, v25
    v_fmac_f32 v24, v26, v26
    v_sub_f32 v26, v251, v25
    v_fmac_f32 v24, v26, v26
    s_nop 1
    v_add_f32_dpp v24, v24, v24 row_ror:1 row_mask:0xf bank_mask:0xf
    s_nop 1
    v_add_f32_dpp v24, v24, v24 row_ror:2 row_mask:0xf bank_mask:0xf
    s_nop 1
    v_add_f32_dpp v24, v24, v24 row_ror:4 row_mask:0xf bank_mask:0xf
    s_nop 1
    v_add_f32_dpp v24, v24, v24 row_ror:8 row_mask:0xf bank_mask:0xf
    s_nop 1
    v_add_f32_dpp v24, v24, v24 row_bcast:15 row_mask:0xa bank_mask:0xf
    s_nop 1
    v_add_f32_dpp v24, v24, v24 row_bcast:31 row_mask:0xc bank_mask:0xf
    s_nop 0
    v_readlane_b32 s34, v24, 63
    s_nop 1
    v_mov_b32 v26, s34
    v_mul_f32 v26, 0x3acccccd, v26
    v_cvt_pk_bf16_f32 v27, v25, v26
    v_lshlrev_b32 v25, 16, v27
    v_and_b32 v26, s35, v27
    v_add_f32 v26, 0x3727c5ac, v26
    v_cvt_pk_bf16_f32 v26, v26, v26
    v_lshlrev_b32 v26, 16, v26
    v_sqrt_f32 v26, v26
    s_nop 0
    v_cvt_pk_bf16_f32 v26, v26, v26
    v_lshlrev_b32 v26, 16, v26
    v_rcp_f32 v27, v26
    v_lshlrev_b32 v31, 3, v0
    v_sub_f32 v242, v242, v25
    v_sub_f32 v243, v243, v25
    v_cvt_pk_bf16_f32 v28, v242, v243
    v_lshlrev_b32 v242, 16, v28
    v_and_b32 v243, s35, v28
    v_mul_f32 v28, v242, v27
    v_mul_f32 v29, v243, v27
    v_fma_f32 v242, -v28, v26, v242
    v_fma_f32 v243, -v29, v26, v243
    v_fmac_f32 v28, v242, v27
    v_fmac_f32 v29, v243, v27
    v_cvt_pk_bf16_f32 v242, v28, v28
    v_cvt_pk_bf16_f32 v243, v29, v29
    ds_write_b64 v31, v[242:243] offset:4096
    v_sub_f32 v244, v244, v25
    v_sub_f32 v245, v245, v25
    v_cvt_pk_bf16_f32 v28, v244, v245
    v_lshlrev_b32 v244, 16, v28
    v_and_b32 v245, s35, v28
    v_mul_f32 v28, v244, v27
    v_mul_f32 v29, v245, v27
    v_fma_f32 v244, -v28, v26, v244
    v_fma_f32 v245, -v29, v26, v245
    v_fmac_f32 v28, v244, v27
    v_fmac_f32 v29, v245, v27
    v_cvt_pk_bf16_f32 v244, v28, v28
    v_cvt_pk_bf16_f32 v245, v29, v29
    ds_write_b64 v31, v[244:245] offset:4608
    v_sub_f32 v246, v246, v25
    v_sub_f32 v247, v247, v25
    v_cvt_pk_bf16_f32 v28, v246, v247
    v_lshlrev_b32 v246, 16, v28
    v_and_b32 v247, s35, v28
    v_mul_f32 v28, v246, v27
    v_mul_f32 v29, v247, v27
    v_fma_f32 v246, -v28, v26, v246
    v_fma_f32 v247, -v29, v26, v247
    v_fmac_f32 v28, v246, v27
    v_fmac_f32 v29, v247, v27
    v_cvt_pk_bf16_f32 v246, v28, v28
    v_cvt_pk_bf16_f32 v247, v29, v29
    ds_write_b64 v31, v[246:247] offset:5120
    v_sub_f32 v248, v248, v25
    v_sub_f32 v249, v249, v25
    v_cvt_pk_bf16_f32 v28, v248, v249
    v_lshlrev_b32 v248, 16, v28
    v_and_b32 v249, s35, v28
    v_mul_f32 v28, v248, v27
    v_mul_f32 v29, v249, v27
    v_fma_f32 v248, -v28, v26, v248
    v_fma_f32 v249, -v29, v26, v249
    v_fmac_f32 v28, v248, v27
    v_fmac_f32 v29, v249, v27
    v_cvt_pk_bf16_f32 v248, v28, v28
    v_cvt_pk_bf16_f32 v249, v29, v29
    ds_write_b64 v31, v[248:249] offset:5632
    v_sub_f32 v250, v250, v25
    v_sub_f32 v251, v251, v25
    v_cvt_pk_bf16_f32 v28, v250, v251
    v_lshlrev_b32 v250, 16, v28
    v_and_b32 v251, s35, v28
    v_mul_f32 v28, v250, v27
    v_mul_f32 v29, v251, v27
    v_fma_f32 v250, -v28, v26, v250
    v_fma_f32 v251, -v29, v26, v251
    v_fmac_f32 v28, v250, v27
    v_fmac_f32 v29, v251, v27
    v_cvt_pk_bf16_f32 v250, v28, v28
    v_cvt_pk_bf16_f32 v251, v29, v29
    ds_write_b64 v31, v[250:251] offset:6144
    v_lshrrev_b32 v30, 3, v2
    v_lshl_add_u32 v30, v3, 1, v30
    v_mul_u32_u24 v29, 384, v30
    v_and_b32 v25, 7, v0
    v_lshl_add_u32 v29, v25, 4, v29
    v_add_u32 v29, 20480, v29
    s_mul_i32 s34, s30, 80
    v_add_lshl_u32 v30, v30, s34, 2
    ds_read_b32 v236, v30 offset:4096
    ds_read_b32 v237, v30 offset:4128
    ds_read_b32 v238, v30 offset:4160
    ds_read_b32 v239, v30 offset:4192
    ds_read_b32 v240, v30 offset:4224
    ds_read_b32 v241, v30 offset:4256
    ds_read_b32 v242, v30 offset:4288
    ds_read_b32 v243, v30 offset:4320
    ds_read_b32 v244, v30 offset:4352
    ds_read_b32 v245, v30 offset:4384
    s_waitcnt lgkmcnt(0)
    ds_read_b128 v[128:131], v29 offset:0
    ds_read_b128 v[132:135], v29 offset:128
    ds_read_b128 v[136:139], v29 offset:256
    ds_read_b128 v[140:143], v29 offset:3072
    ds_read_b128 v[144:147], v29 offset:3200
    ds_read_b128 v[148:151], v29 offset:3328
    ds_read_b128 v[152:155], v29 offset:6144
    ds_read_b128 v[156:159], v29 offset:6272
    ds_read_b128 v[160:163], v29 offset:6400
    ds_read_b128 v[164:167], v29 offset:9216
    ds_read_b128 v[168:171], v29 offset:9344
    ds_read_b128 v[172:175], v29 offset:9472
    v_lshrrev_b32 v24, 1, v3
    v_mul_u32_u24 v24, 768, v24
    v_and_b32 v26, 1, v3
    v_lshl_add_u32 v24, v26, 7, v24
    v_lshl_add_u32 v24, v25, 4, v24
    v_lshrrev_b32 v26, 5, v0
    v_lshlrev_b32 v26, 7, v26
    v_lshl_add_u32 v26, v25, 4, v26
    v_bfe_u32 v25, v0, 3, 2
    v_lshl_add_u32 v26, v25, 2, v26
    v_add_u32 v26, 6656, v26
    s_waitcnt vmcnt(0)
    global_load_dwordx4 v[44:47], v4, s[6:7] offset:0 nt
    global_load_dwordx4 v[48:51], v4, s[6:7] offset:256 nt
    global_load_dwordx4 v[52:55], v4, s[6:7] offset:512 nt
    s_cmp_eq_u32 s66, 6
    s_cselect_b32 s67, -1376256, s68
    v_add_u32 v4, s67, v4
    s_waitcnt lgkmcnt(0)
    ds_read_b128 v[176:179], v29 offset:12288
    ds_read_b128 v[180:183], v29 offset:12416
    ds_read_b128 v[184:187], v29 offset:12544
    ds_read_b128 v[188:191], v29 offset:15360
    ds_read_b128 v[192:195], v29 offset:15488
    ds_read_b128 v[196:199], v29 offset:15616
    ds_read_b128 v[200:203], v29 offset:18432
    ds_read_b128 v[204:207], v29 offset:18560
    ds_read_b128 v[208:211], v29 offset:18688
    ds_read_b128 v[212:215], v29 offset:21504
    ds_read_b128 v[216:219], v29 offset:21632
    ds_read_b128 v[220:223], v29 offset:21760
    v_and_b32 v16, v12, v236
    v_and_b32 v17, v13, v236
    v_and_b32 v18, v14, v236
    v_and_b32 v19, v15, v236
    s_nop 1
    v_mfma_f32_16x16x32_bf16 v[224:227], v[128:131], v[16:19], 0
    v_mfma_f32_16x16x32_bf16 v[228:231], v[132:135], v[16:19], 0
    v_mfma_f32_16x16x32_bf16 v[232:235], v[136:139], v[16:19], 0
    v_and_b32 v20, v12, v237
    v_and_b32 v21, v13, v237
    v_and_b32 v22, v14, v237
    v_and_b32 v23, v15, v237
    s_nop 1
    v_mfma_f32_16x16x32_bf16 v[224:227], v[140:143], v[20:23], v[224:227]
    v_mfma_f32_16x16x32_bf16 v[228:231], v[144:147], v[20:23], v[228:231]
    v_mfma_f32_16x16x32_bf16 v[232:235], v[148:151], v[20:23], v[232:235]
    v_and_b32 v16, v12, v238
    v_and_b32 v17, v13, v238
    v_and_b32 v18, v14, v238
    v_and_b32 v19, v15, v238
    s_nop 1
    v_mfma_f32_16x16x32_bf16 v[224:227], v[152:155], v[16:19], v[224:227]
    v_mfma_f32_16x16x32_bf16 v[228:231], v[156:159], v[16:19], v[228:231]
    v_mfma_f32_16x16x32_bf16 v[232:235], v[160:163], v[16:19], v[232:235]
    v_and_b32 v20, v12, v239
    v_and_b32 v21, v13, v239
    v_and_b32 v22, v14, v239
    v_and_b32 v23, v15, v239
    s_nop 1
    v_mfma_f32_16x16x32_bf16 v[224:227], v[164:167], v[20:23], v[224:227]
    v_mfma_f32_16x16x32_bf16 v[228:231], v[168:171], v[20:23], v[228:231]
    v_mfma_f32_16x16x32_bf16 v[232:235], v[172:175], v[20:23], v[232:235]
    s_waitcnt lgkmcnt(0)
    ds_read_b128 v[128:131], v29 offset:24576
    ds_read_b128 v[132:135], v29 offset:24704
    ds_read_b128 v[136:139], v29 offset:24832
    ds_read_b128 v[140:143], v29 offset:27648
    ds_read_b128 v[144:147], v29 offset:27776
    ds_read_b128 v[148:151], v29 offset:27904
    v_and_b32 v16, v12, v240
    v_and_b32 v17, v13, v240
    v_and_b32 v18, v14, v240
    v_and_b32 v19, v15, v240
    s_nop 1
    v_mfma_f32_16x16x32_bf16 v[224:227], v[176:179], v[16:19], v[224:227]
    v_mfma_f32_16x16x32_bf16 v[228:231], v[180:183], v[16:19], v[228:231]
    v_mfma_f32_16x16x32_bf16 v[232:235], v[184:187], v[16:19], v[232:235]
    v_and_b32 v20, v12, v241
    v_and_b32 v21, v13, v241
    v_and_b32 v22, v14, v241
    v_and_b32 v23, v15, v241
    s_nop 1
    v_mfma_f32_16x16x32_bf16 v[224:227], v[188:191], v[20:23], v[224:227]
    v_mfma_f32_16x16x32_bf16 v[228:231], v[192:195], v[20:23], v[228:231]
    v_mfma_f32_16x16x32_bf16 v[232:235], v[196:199], v[20:23], v[232:235]
    v_and_b32 v16, v12, v242
    v_and_b32 v17, v13, v242
    v_and_b32 v18, v14, v242
    v_and_b32 v19, v15, v242
    s_nop 1
    v_mfma_f32_16x16x32_bf16 v[224:227], v[200:203], v[16:19], v[224:227]
    v_mfma_f32_16x16x32_bf16 v[228:231], v[204:207], v[16:19], v[228:231]
    v_mfma_f32_16x16x32_bf16 v[232:235], v[208:211], v[16:19], v[232:235]
    v_and_b32 v20, v12, v243
    v_and_b32 v21, v13, v243
    v_and_b32 v22, v14, v243
    v_and_b32 v23, v15, v243
    s_nop 1
    v_mfma_f32_16x16x32_bf16 v[224:227], v[212:215], v[20:23], v[224:227]
    v_mfma_f32_16x16x32_bf16 v[228:231], v[216:219], v[20:23], v[228:231]
    v_mfma_f32_16x16x32_bf16 v[232:235], v[220:223], v[20:23], v[232:235]
    s_waitcnt lgkmcnt(0)
    v_and_b32 v16, v12, v244
    v_and_b32 v17, v13, v244
    v_and_b32 v18, v14, v244
    v_and_b32 v19, v15, v244
    s_nop 1
    v_mfma_f32_16x16x32_bf16 v[224:227], v[128:131], v[16:19], v[224:227]
    v_mfma_f32_16x16x32_bf16 v[228:231], v[132:135], v[16:19], v[228:231]
    v_mfma_f32_16x16x32_bf16 v[232:235], v[136:139], v[16:19], v[232:235]
    v_and_b32 v20, v12, v245
    v_and_b32 v21, v13, v245
    v_and_b32 v22, v14, v245
    v_and_b32 v23, v15, v245
    s_nop 1
    v_mfma_f32_16x16x32_bf16 v[224:227], v[140:143], v[20:23], v[224:227]
    v_mfma_f32_16x16x32_bf16 v[228:231], v[144:147], v[20:23], v[228:231]
    v_mfma_f32_16x16x32_bf16 v[232:235], v[148:151], v[20:23], v[232:235]
    s_mov_b64 exec, s[42:43]
    s_nop 4
    ds_write_b128 v24, v[224:227] offset:6656
    ds_write_b128 v24, v[228:231] offset:6912
    ds_write_b128 v24, v[232:235] offset:7168
    s_mov_b64 exec, -1
    ds_read2st64_b32 v[16:17], v26 offset0:0 offset1:3
    ds_read2st64_b32 v[18:19], v26 offset0:1 offset1:4
    ds_read2st64_b32 v[20:21], v26 offset0:2 offset1:5
    s_getreg_b32 s53, hwreg(HW_REG_XCC_ID, 0, 3)
    s_andn2_b32 s54, s36, 7
    s_or_b32 s54, s54, s53
    s_lshl3_add_u32 s47, s29, s30
    s_lshl_b32 s34, s47, 10
    s_add_u32 s34, s34, 65536
    v_lshl_add_u32 v10, v0, 4, s34
    s_lshl_b32 s34, s29, 13
    s_add_u32 s34, s34, 69632
    v_lshl_add_u32 v31, v0, 4, s34
    s_waitcnt lgkmcnt(0)
    v_add_f32 v252, v16, v17
    v_add_f32 v253, v18, v19
    v_add_f32 v254, v20, v21
    v_mov_b32 v255, s54
    global_store_dwordx4 v10, v[252:255], s[24:25]
    s_setprio 0
    s_waitcnt vmcnt(1)
    global_load_dwordx4 v[56:59], v4, s[6:7] offset:0 nt
    global_load_dwordx4 v[60:63], v4, s[6:7] offset:256 nt
    global_load_dwordx4 v[64:67], v4, s[6:7] offset:512 nt
    s_cmp_eq_u32 s66, 5
    s_cselect_b32 s67, -1376256, s68
    v_add_u32 v4, s67, v4
    v_and_b32 v28, 3, v2
    v_lshl_add_u32 v28, v3, 2, v28
    v_lshlrev_b32 v28, 4, v28
    v_add_u32 v28, 256, v28
    v_mov_b32 v24, 192
    v_add_u32 v29, 256, v28
    v_subrev_u32 v30, 128, v28
    v_cmp_gt_u32 vcc, 32, v0
    s_nop 1
    v_cndmask_b32 v29, v30, v29, vcc
    v_add_u32 v30, 128, v28
    v_cndmask_b32 v28, v24, v28, s[40:41]
    v_cndmask_b32 v29, v24, v29, s[42:43]
    v_cndmask_b32 v30, v24, v30, s[44:45]
    v_and_b32 v5, 31, v0
    s_lshl_b32 s34, s27, 15
    s_add_u32 s34, s34, 65548
    v_lshl_add_u32 v6, v5, 10, s34
    s_waitcnt vmcnt(0)
    global_load_dwordx4 v[68:71], v4, s[6:7] offset:0 nt
    global_load_dwordx4 v[72:75], v4, s[6:7] offset:256 nt
    global_load_dwordx4 v[76:79], v4, s[6:7] offset:512 nt
    s_cmp_eq_u32 s66, 4
    s_cselect_b32 s67, -1376256, s68
    v_add_u32 v4, s67, v4
    global_load_dwordx4 v[128:131], v31, s[24:25] offset:-4096 sc1
    global_load_dwordx4 v[132:135], v31, s[24:25] offset:-3072 sc1
    global_load_dwordx4 v[136:139], v31, s[24:25] offset:-2048 sc1
    global_load_dwordx4 v[140:143], v31, s[24:25] offset:-1024 sc1
    global_load_dwordx4 v[144:147], v31, s[24:25] offset:0 sc1
    global_load_dwordx4 v[148:151], v31, s[24:25] offset:1024 sc1
    global_load_dwordx4 v[152:155], v31, s[24:25] offset:2048 sc1
    global_load_dwordx4 v[156:159], v31, s[24:25] offset:3072 sc1
    s_waitcnt vmcnt(8)
    global_load_dwordx4 v[80:83], v4, s[6:7] offset:0 nt
    global_load_dwordx4 v[84:87], v4, s[6:7] offset:256 nt
    global_load_dwordx4 v[88:91], v4, s[6:7] offset:512 nt
    s_cmp_eq_u32 s66, 3
    s_cselect_b32 s67, -1376256, s68
    v_add_u32 v4, s67, v4
    s_waitcnt vmcnt(3)
    s_mov_b32 s46, 0
L_qchk:
    v_min3_u32 v20, v131, v135, v139
    v_max3_u32 v21, v131, v135, v139
    v_min3_u32 v20, v20, v143, v147
    v_max3_u32 v21, v21, v143, v147
    v_min3_u32 v20, v20, v151, v155
    v_max3_u32 v21, v21, v151, v155
    v_min_u32 v20, v20, v159
    v_max_u32 v21, v21, v159
    v_xor_b32 v20, s36, v20
    v_xor_b32 v21, s36, v21
    v_or_b32 v20, v20, v21
    v_cmp_lt_u32 vcc, 7, v20
    s_cbranch_vccz L_qall
    s_cmp_lg_u32 s46, 1
    s_cbranch_scc1 L_qrep
    global_store_dwordx4 v10, v[252:255], s[24:25] sc1
L_qrep:
    global_load_dwordx4 v[128:131], v31, s[24:25] offset:-4096 sc1
    global_load_dwordx4 v[132:135], v31, s[24:25] offset:-3072 sc1
    global_load_dwordx4 v[136:139], v31, s[24:25] offset:-2048 sc1
    global_load_dwordx4 v[140:143], v31, s[24:25] offset:-1024 sc1
    global_load_dwordx4 v[144:147], v31, s[24:25] offset:0 sc1
    global_load_dwordx4 v[148:151], v31, s[24:25] offset:1024 sc1
    global_load_dwordx4 v[152:155], v31, s[24:25] offset:2048 sc1
    global_load_dwordx4 v[156:159], v31, s[24:25] offset:3072 sc1
    s_add_u32 s46, s46, 1
    s_cmp_lt_u32 s46, 131072
    s_waitcnt vmcnt(0)
    s_cbranch_scc1 L_qchk
L_qall:
    v_add_f32 v16, v128, v132
    v_add_f32 v17, v136, v140
    v_add_f32 v18, v144, v148
    v_add_f32 v19, v152, v156
    v_add_f32 v16, v16, v17
    v_add_f32 v18, v18, v19
    v_add_f32 v16, v16, v18
    v_cvt_pk_bf16_f32 v20, v16, v16
    v_add_f32 v16, v129, v133
    v_add_f32 v17, v137, v141
    v_add_f32 v18, v145, v149
    v_add_f32 v19, v153, v157
    v_add_f32 v16, v16, v17
    v_add_f32 v18, v18, v19
    v_add_f32 v16, v16, v18
    v_cvt_pk_bf16_f32 v21, v16, v16
    v_add_f32 v16, v130, v134
    v_add_f32 v17, v138, v142
    v_add_f32 v18, v146, v150
    v_add_f32 v19, v154, v158
    v_add_f32 v16, v16, v17
    v_add_f32 v18, v18, v19
    v_add_f32 v16, v16, v18
    v_cvt_pk_bf16_f32 v22, v16, v16
    v_lshlrev_b32 v24, 1, v0
    ds_write_b16 v24, v20 offset:256
    ds_write_b16 v24, v21 offset:384
    ds_write_b16 v24, v22 offset:512
    v_mov_b32 v25, 1
    ds_write_b32 v11, v25 offset:0
    s_waitcnt vmcnt(0)
    global_load_dwordx4 v[92:95], v4, s[6:7] offset:0 nt
    global_load_dwordx4 v[96:99], v4, s[6:7] offset:256 nt
    global_load_dwordx4 v[100:103], v4, s[6:7] offset:512 nt
    s_cmp_eq_u32 s66, 2
    s_cselect_b32 s67, -1376256, s68
    v_add_u32 v4, s67, v4
    s_waitcnt vmcnt(0)
    global_load_dwordx4 v[104:107], v4, s[6:7] offset:0 nt
    global_load_dwordx4 v[108:111], v4, s[6:7] offset:256 nt
    global_load_dwordx4 v[112:115], v4, s[6:7] offset:512 nt
    s_cmp_eq_u32 s66, 1
    s_cselect_b32 s67, -1376256, s68
    v_add_u32 v4, s67, v4
    global_load_dword v164, v6, s[24:25] sc1
    s_waitcnt vmcnt(1)
    global_load_dwordx4 v[116:119], v4, s[6:7] offset:0 nt
    global_load_dwordx4 v[120:123], v4, s[6:7] offset:256 nt
    global_load_dwordx4 v[124:127], v4, s[6:7] offset:512 nt
    s_waitcnt vmcnt(3)
    s_mov_b32 s46, 0
L_fchk:
    v_xor_b32 v20, s36, v164
    v_cmp_lt_u32 vcc, 7, v20
    s_cbranch_vccz L_fall
    s_cmp_lg_u32 s46, 1
    s_cbranch_scc1 L_frep
    global_store_dwordx4 v10, v[252:255], s[24:25] sc1
L_frep:
    global_load_dword v164, v6, s[24:25] sc1
    s_add_u32 s46, s46, 1
    s_cmp_lt_u32 s46, 131072
    s_waitcnt vmcnt(0)
    s_cbranch_scc1 L_fchk
L_fall:
    v_mov_b32 v21, s36
    s_cmp_lg_u32 s28, 0
    s_cbranch_scc1 L_nolead
    s_lshl_b32 s34, s27, 7
    s_add_u32 s34, s34, 4096
    v_mov_b32 v20, s34
    s_mov_b64 exec, 1
    global_store_dword v20, v21, s[24:25] sc1
    s_mov_b64 exec, -1
L_nolead:
    s_mov_b32 s64, 2
    v_cmp_ne_u32 vcc, s54, v164
    s_cbranch_vccz L_vphase
    s_mov_b32 s64, 1
    global_store_dwordx4 v10, v[252:255], s[24:25] sc1
    s_add_u32 s34, s69, 851968
    v_lshl_add_u32 v20, v0, 3, s34
    v_mov_b32 v22, -1
    v_mov_b32 v23, -1
    s_mov_b32 exec_hi, 0xffff
    global_store_dwordx2 v20, v[22:23], s[24:25] sc1
    global_store_dwordx2 v20, v[22:23], s[24:25] offset:384 sc1
    global_store_dwordx2 v20, v[22:23], s[24:25] offset:768 sc1
    s_mov_b64 exec, -1
    s_lshl_b32 s34, s27, 7
    s_add_u32 s34, s34, 8192
    v_lshl_add_u32 v6, v5, 2, s34
    s_lshl2_add_u32 s34, s28, s34
    v_mov_b32 v20, s34
    s_waitcnt vmcnt(0)
    s_mov_b64 exec, 1
    global_store_dword v20, v21, s[24:25] sc1
    s_mov_b64 exec, -1
    s_mov_b32 s46, 0
L_schk:
    global_load_dword v164, v6, s[24:25] sc1
    s_add_u32 s46, s46, 1
    s_cmp_ge_u32 s46, 131072
    s_waitcnt vmcnt(0)
    v_cmp_ne_u32 vcc, s36, v164
    s_cbranch_scc1 L_vphase
    s_cbranch_vccnz L_schk
    s_branch L_vphase
L_gfstep:
    s_waitcnt vmcnt(1)
    global_load_dwordx4 v[176:179], v8, s[8:9] offset:0 nt
    global_load_dwordx4 v[180:183], v8, s[8:9] offset:256 nt
    global_load_dwordx4 v[184:187], v8, s[8:9] offset:512 nt
    s_cmp_eq_u32 s66, 3
    s_cselect_b32 s67, -1376256, s68
    v_add_u32 v8, s67, v8
    s_mov_b32 s46, 0
    s_waitcnt vmcnt(3)
L_gfchk:
    v_cmp_ne_u32 vcc, s36, v17
    s_cbranch_vccz L_gfok
    global_load_dword v17, v16, s[24:25] sc1
    s_add_u32 s46, s46, 1
    s_cmp_lt_u32 s46, 131072
    s_waitcnt vmcnt(0)
    s_cbranch_scc1 L_gfchk
L_gfok:
    v_mov_b32 v25, s64
    ds_write_b32 v11, v25 offset:8
    s_cmp_lg_u32 s2, 255
    s_cbranch_scc1 L_gfback
    s_mov_b64 exec, 1
    global_store_dword v11, v17, s[24:25] sc1
    s_mov_b64 exec, -1
    s_branch L_gfback
L_code_end:
    .fill (16384 + 256 - (L_code_end - sequential_preLN__sliding_block_cached__dense_activation_relu__decode_kernel)) / 4, 4, 0xbf800000
.section .rodata,"a"
.p2align 6
.amdhsa_kernel sequential_preLN__sliding_block_cached__dense_activation_relu__decode_kernel
  .amdhsa_next_free_vgpr 256
  .amdhsa_next_free_sgpr 102
  .amdhsa_accum_offset 256
  .amdhsa_group_segment_fixed_size 0
  .amdhsa_kernarg_size 88
  .amdhsa_user_sgpr_count 2
  .amdhsa_user_sgpr_kernarg_segment_ptr 1
  .amdhsa_system_sgpr_workgroup_id_x 1
  .amdhsa_float_denorm_mode_32 3
.end_amdhsa_kernel
```
